```python
import torch

def _softmax(x, axis=-1):
    return torch.softmax(x, dim=axis)

def _gelu(x):
    return torch.nn.functional.gelu(x, approximate='tanh')

def _silu(x):
    return torch.nn.functional.silu(x)

def _sigmoid(x):
    return torch.sigmoid(x)

def _layernorm(x, axis=-1, eps=1e-05):
    m = x.mean(dim=axis, keepdim=True)
    v = x.var(dim=axis, keepdim=True, unbiased=False)
    return (x - m) / torch.sqrt(v + eps)

def _scatter_add(tgt, idx, src, axis=0):
    return tgt.clone().index_add_(axis, idx, src)

def _segment_sum(src, seg, n):
    out = torch.zeros((n,) + src.shape[1:], dtype=src.dtype)
    return out.index_add_(0, seg, src)

def _pad(x, pw):
    flat = tuple((v for pair in reversed(pw) for v in pair))
    return torch.nn.functional.pad(x, flat)
kernel_name = 'standalone__tree_speculative_verify_tree_attention_over_candidate_token_tree__decode'

def setup_inputs():

    _w = lambda a: (lambda t: t.to(torch.bfloat16) if t.is_floating_point() else t)(torch.as_tensor(a))
    B, Hq, Hkv, T, C, D = (1, 32, 8, 1, 32768, 128)
    tree_mask = torch.zeros((B, T, T), dtype=float)
    for b in range(B):
        parent = torch.zeros(T, dtype=torch.int64)
        for i in range(1, T):
            parent[i] = int(torch.randint(0, i, (1,)).item())
        for i in range(T):
            j = i
            tree_mask[b, i, j] = 1.0
            while j > 0:
                j = parent[j]
                tree_mask[b, i, j] = 1.0
    return {'q': _w((lambda *s: torch.randn(*s, dtype=torch.bfloat16) * 0.8)(B, Hq, T, D)), 'k_cache': _w((lambda *s: torch.randn(*s, dtype=torch.bfloat16) * 0.8)(B, Hkv, C, D)), 'v_cache': _w((lambda *s: torch.randn(*s, dtype=torch.bfloat16) * 0.05)(B, Hkv, C, D)), 'k_tree': _w((lambda *s: torch.randn(*s, dtype=torch.bfloat16) * 0.8)(B, Hkv, T, D)), 'v_tree': _w((lambda *s: torch.randn(*s, dtype=torch.bfloat16) * 0.05)(B, Hkv, T, D)), 'tree_mask': _w(tree_mask)}

def reference(q, k_cache, v_cache, k_tree, v_tree, tree_mask):
    B, Hq, T, D = q.shape
    Hkv, C = (k_cache.shape[1], k_cache.shape[2])
    rep = Hq // Hkv
    kc = (lambda x, n, axis: torch.repeat_interleave(x, n, dim=axis))(k_cache, rep, axis=1)
    vc = (lambda x, n, axis: torch.repeat_interleave(x, n, dim=axis))(v_cache, rep, axis=1)
    kt = (lambda x, n, axis: torch.repeat_interleave(x, n, dim=axis))(k_tree, rep, axis=1)
    vt = (lambda x, n, axis: torch.repeat_interleave(x, n, dim=axis))(v_tree, rep, axis=1)
    k = torch.concatenate([kc, kt], axis=2)
    v = torch.concatenate([vc, vt], axis=2)
    scale = D ** (-0.5)
    scores = torch.einsum('bhqd,bhkd->bhqk', q, k) * scale
    ctx_mask = torch.ones((B, 1, T, C), dtype=scores.dtype)
    tm = tree_mask[:, None, :, :].clone()
    full_mask = torch.concatenate([ctx_mask, tm], axis=-1)
    scores = scores + (1.0 - full_mask) * -1000000000.0
    p = _softmax(scores, axis=-1)
    return torch.einsum('bhqk,bhkd->bhqd', p, v)
```

```asm
; @launch grid=(256,1,1) block=(256,1,1) lds=9472
.amdgcn_target "amdgcn-amd-amdhsa--gfx950"
.text
.globl standalone__tree_speculative_verify_tree_attention_over_candidate_token_tree__decode_kernel
.p2align 8
.type standalone__tree_speculative_verify_tree_attention_over_candidate_token_tree__decode_kernel,@function
standalone__tree_speculative_verify_tree_attention_over_candidate_token_tree__decode_kernel:
    s_load_dwordx2 s[28:29], s[0:1], 8
    s_load_dwordx2 s[4:5], s[0:1], 0
    s_cmp_ge_u32 s2, 256
    s_cbranch_scc1 L_end
    v_lshrrev_b32 v2, 6, v0
    v_and_b32 v5, 1, v0
    v_readfirstlane_b32 s24, v2
    v_bfe_u32 v4, v0, 4, 2
    s_and_b32 s22, s2, 7
    s_lshr_b32 s23, s2, 3
    v_lshlrev_b32 v5, 22, v5
    v_bfe_u32 v6, v0, 1, 1
    v_lshl_add_u32 v5, v6, 9, v5
    v_bfe_u32 v6, v0, 2, 1
    v_lshl_add_u32 v5, v6, 17, v5
    v_bfe_u32 v6, v0, 3, 1
    s_lshl_b32 s25, s22, 23
    s_bfe_u32 s26, s23, 0x10000
    s_lshl_b32 s26, s26, 11
    s_or_b32 s25, s25, s26
    s_bfe_u32 s26, s23, 0x10001
    s_lshl_b32 s26, s26, 14
    s_or_b32 s25, s25, s26
    s_bfe_u32 s26, s23, 0x10002
    s_lshl_b32 s26, s26, 16
    s_or_b32 s25, s25, s26
    s_bfe_u32 s26, s23, 0x20003
    s_lshl_b32 s26, s26, 20
    s_or_b32 s25, s25, s26
    v_lshl_add_u32 v5, v6, 6, v5
    v_lshl_add_u32 v5, v4, 4, v5
    s_lshl_b32 s26, s24, 12
    s_or_b32 s25, s25, s26
    s_mov_b32 s30, 0x4000000
    s_mov_b32 s31, 0x20000
    v_and_b32 v3, 15, v0
    v_and_b32 v1, 63, v0
    v_lshrrev_b32 v7, 2, v3
    v_lshlrev_b32 v7, 8, v7
    v_bfe_u32 v6, v0, 1, 1
    v_lshl_add_u32 v7, v6, 6, v7
    v_lshl_add_u32 v7, v4, 4, v7
    s_lshl_b32 s27, s22, 10
    v_add_u32 v7, s27, v7
    s_waitcnt lgkmcnt(0)
    buffer_load_dwordx4 a[0:3], v5, s[28:31], s25 offen offset:0 nt
    s_add_u32 s26, s25, 0x40000
    buffer_load_dwordx4 a[4:7], v5, s[28:31], s26 offen offset:0 nt
    global_load_dwordx4 v[8:11], v7, s[4:5] offset:0
    global_load_dwordx4 v[12:15], v7, s[4:5] offset:128
    buffer_load_dwordx4 a[8:11], v5, s[28:31], s25 offen offset:128 nt
    s_load_dwordx8 s[8:15], s[0:1], 16
    s_load_dwordx4 s[16:19], s[0:1], 48
    s_load_dwordx2 s[20:21], s[0:1], 64
    buffer_load_dwordx4 a[12:15], v5, s[28:31], s26 offen offset:128 nt
    s_add_u32 s38, s25, 0x80000
    buffer_load_dwordx4 a[16:19], v5, s[28:31], s38 offen offset:0 nt
    s_add_u32 s39, s25, 0xc0000
    buffer_load_dwordx4 a[20:23], v5, s[28:31], s39 offen offset:0 nt
    s_waitcnt lgkmcnt(0)
    v_mov_b32 v88, 0xc0000
    v_mov_b32 v93, 1
    v_mov_b32 v94, 0
    v_mov_b32 v95, 0
    s_cmp_eq_u32 s25, 0
    s_cbranch_scc1 L_el1
L_el1b:
    v_and_b32 v2, 3, v3
    v_mov_b32 v7, 0xffff
    v_and_b32 v0, 1, v2
    v_lshlrev_b32 v0, 4, v0
    v_lshlrev_b32 v7, v0, v7
    v_cmp_gt_u32 vcc, 2, v2
    s_mov_b32 s40, 0x3e0293ee
    v_mov_b32 v0, 0xff800000
    v_cndmask_b32 v2, 0, v7, vcc
    v_cndmask_b32 v7, v7, 0, vcc
    s_waitcnt vmcnt(7)
    buffer_load_dwordx4 a[24:27], v5, s[28:31], s38 offen offset:128 nt
    s_waitcnt vmcnt(7)
    buffer_load_dwordx4 a[28:31], v5, s[28:31], s39 offen offset:128 nt
    s_waitcnt vmcnt(5)
    s_add_u32 s92, s25, 0x8000
    buffer_load_dwordx4 a[32:35], v5, s[28:31], s92 offen offset:0 nt
    s_getreg_b32 s93, hwreg(HW_REG_XCC_ID, 0, 4)
    s_and_b32 s93, s93, 7
    s_lshl_b32 s93, s93, 2
    s_cmp_eq_u32 s24, 0
    s_cselect_b32 s27, s23, 0
    s_cmp_ge_u32 s27, 24
    s_cbranch_scc1 L_rep
L_repb:
    s_waitcnt vmcnt(5)
    s_add_u32 s26, s25, 0x48000
    buffer_load_dwordx4 a[36:39], v5, s[28:31], s26 offen offset:0 nt
    v_mfma_f32_16x16x32_bf16 v[24:27], a[0:3], v[8:11], 0
    v_mfma_f32_16x16x32_bf16 v[28:31], a[4:7], v[8:11], 0
    v_mfma_f32_16x16x32_bf16 v[24:27], a[8:11], v[12:15], v[24:27]
    v_mfma_f32_16x16x32_bf16 v[28:31], a[12:15], v[12:15], v[28:31]
    s_waitcnt vmcnt(5)
    buffer_load_dwordx4 a[40:43], v5, s[28:31], s92 offen offset:128 nt
    s_waitcnt vmcnt(5)
    buffer_load_dwordx4 a[44:47], v5, s[28:31], s26 offen offset:128 nt
    s_waitcnt vmcnt(5)
    s_add_u32 s38, s25, 0x88000
    buffer_load_dwordx4 a[48:51], v5, s[28:31], s38 offen offset:0 nt
    s_waitcnt vmcnt(5)
    s_add_u32 s39, s25, 0xc8000
    buffer_load_dwordx4 a[52:55], v5, s[28:31], s39 offen offset:0 nt
    v_mfma_f32_16x16x32_bf16 v[32:35], a[16:19], v[8:11], 0
    v_mfma_f32_16x16x32_bf16 v[36:39], a[20:23], v[8:11], 0
    v_mfma_f32_16x16x32_bf16 v[32:35], a[24:27], v[12:15], v[32:35]
    v_mfma_f32_16x16x32_bf16 v[36:39], a[28:31], v[12:15], v[36:39]
    s_nop 3
    v_permlane32_swap_b32 v24, v28
    v_permlane32_swap_b32 v25, v29
    v_permlane32_swap_b32 v26, v30
    v_permlane32_swap_b32 v27, v31
    v_add_f32_dpp v128, v28, v24 quad_perm:[2,3,2,3] row_mask:0xf bank_mask:0xf
    v_add_f32_dpp v130, v29, v25 quad_perm:[2,3,2,3] row_mask:0xf bank_mask:0xf
    v_add_f32_dpp v132, v30, v26 quad_perm:[2,3,2,3] row_mask:0xf bank_mask:0xf
    v_add_f32_dpp v134, v31, v27 quad_perm:[2,3,2,3] row_mask:0xf bank_mask:0xf
    v_max3_f32 v0, v0, v128, v130
    v_max3_f32 v0, v0, v132, v134
    s_waitcnt vmcnt(5)
    buffer_load_dwordx4 a[56:59], v5, s[28:31], s38 offen offset:128 nt
    s_waitcnt vmcnt(5)
    buffer_load_dwordx4 a[60:63], v5, s[28:31], s39 offen offset:128 nt
    s_waitcnt vmcnt(5)
    buffer_load_dwordx4 a[0:3], v5, s[28:31], s25 offen offset:256 nt
    s_cmp_eq_u32 s25, 0
    s_cbranch_scc1 L_el2
L_el2b:
    s_waitcnt vmcnt(5)
    s_add_u32 s92, s25, 0x40000
    buffer_load_dwordx4 a[4:7], v5, s[28:31], s92 offen offset:256 nt
    v_mfma_f32_16x16x32_bf16 v[24:27], a[32:35], v[8:11], 0
    v_mfma_f32_16x16x32_bf16 v[28:31], a[36:39], v[8:11], 0
    v_mfma_f32_16x16x32_bf16 v[24:27], a[40:43], v[12:15], v[24:27]
    v_mfma_f32_16x16x32_bf16 v[28:31], a[44:47], v[12:15], v[28:31]
    v_permlane32_swap_b32 v32, v36
    v_permlane32_swap_b32 v33, v37
    v_permlane32_swap_b32 v34, v38
    v_permlane32_swap_b32 v35, v39
    v_add_f32_dpp v136, v36, v32 quad_perm:[2,3,2,3] row_mask:0xf bank_mask:0xf
    v_add_f32_dpp v138, v37, v33 quad_perm:[2,3,2,3] row_mask:0xf bank_mask:0xf
    v_add_f32_dpp v140, v38, v34 quad_perm:[2,3,2,3] row_mask:0xf bank_mask:0xf
    v_add_f32_dpp v142, v39, v35 quad_perm:[2,3,2,3] row_mask:0xf bank_mask:0xf
    v_max3_f32 v0, v0, v136, v138
    v_max3_f32 v0, v0, v140, v142
    s_waitcnt vmcnt(5)
    buffer_load_dwordx4 a[8:11], v5, s[28:31], s25 offen offset:384 nt
    s_waitcnt vmcnt(5)
    buffer_load_dwordx4 a[12:15], v5, s[28:31], s92 offen offset:384 nt
    s_waitcnt vmcnt(5)
    s_add_u32 s26, s25, 0x80000
    buffer_load_dwordx4 a[16:19], v5, s[28:31], s26 offen offset:256 nt
    s_waitcnt vmcnt(5)
    s_add_u32 s38, s25, 0xc0000
    buffer_load_dwordx4 a[20:23], v5, s[28:31], s38 offen offset:256 nt
    v_mfma_f32_16x16x32_bf16 v[32:35], a[48:51], v[8:11], 0
    v_mfma_f32_16x16x32_bf16 v[36:39], a[52:55], v[8:11], 0
    v_mfma_f32_16x16x32_bf16 v[32:35], a[56:59], v[12:15], v[32:35]
    v_mfma_f32_16x16x32_bf16 v[36:39], a[60:63], v[12:15], v[36:39]
    v_permlane32_swap_b32 v24, v28
    v_permlane32_swap_b32 v25, v29
    v_permlane32_swap_b32 v26, v30
    v_permlane32_swap_b32 v27, v31
    v_add_f32_dpp v144, v28, v24 quad_perm:[2,3,2,3] row_mask:0xf bank_mask:0xf
    v_add_f32_dpp v146, v29, v25 quad_perm:[2,3,2,3] row_mask:0xf bank_mask:0xf
    v_add_f32_dpp v148, v30, v26 quad_perm:[2,3,2,3] row_mask:0xf bank_mask:0xf
    v_add_f32_dpp v150, v31, v27 quad_perm:[2,3,2,3] row_mask:0xf bank_mask:0xf
    v_max3_f32 v0, v0, v144, v146
    v_max3_f32 v0, v0, v148, v150
    s_waitcnt vmcnt(5)
    buffer_load_dwordx4 a[24:27], v5, s[28:31], s26 offen offset:384 nt
    s_waitcnt vmcnt(5)
    buffer_load_dwordx4 a[28:31], v5, s[28:31], s38 offen offset:384 nt
    s_waitcnt vmcnt(5)
    s_add_u32 s39, s25, 0x8000
    buffer_load_dwordx4 a[32:35], v5, s[28:31], s39 offen offset:256 nt
    s_bfe_u32 s41, s23, 0x20001
    s_xor_b32 s43, s22, 0
    s_lshl_b32 s42, s43, 2
    s_add_u32 s42, s42, s41
    s_lshl_b32 s42, s42, 8
    s_lshl_b32 s43, s43, 8
    v_lshl_add_u32 v125, v1, 2, s42
    v_lshl_add_u32 v126, v1, 2, s43
    s_and_b32 s56, s23, 1
    s_lshl_b32 s56, s56, 2
    s_add_u32 s56, s56, s24
    s_lshl_b32 s56, s56, 5
    v_and_b32 v23, 3, v1
    v_lshl_add_u32 v23, v23, 2, v4
    v_lshl_add_u32 v23, v23, 1, s56
    v_add_u32 v18, s43, v23
    v_mov_b32 v127, 0
    v_lshrrev_b32 v124, 2, v3
    s_lshl_b32 s27, s24, 2
    v_lshl_add_u32 v124, v124, 4, s27
    v_mov_b32 v20, 0
    v_lshlrev_b32 v6, 17, v4
    v_lshl_add_u32 v6, v3, 4, v6
    s_mov_b32 s32, s8
    s_mov_b32 s33, s9
    s_mov_b32 s34, 0x4000000
    s_mov_b32 s35, 0x20000
    s_waitcnt vmcnt(5)
    s_add_u32 s92, s25, 0x48000
    buffer_load_dwordx4 a[36:39], v5, s[28:31], s92 offen offset:256 nt
    v_mfma_f32_16x16x32_bf16 v[24:27], a[0:3], v[8:11], 0
    v_mfma_f32_16x16x32_bf16 v[28:31], a[4:7], v[8:11], 0
    v_mfma_f32_16x16x32_bf16 v[24:27], a[8:11], v[12:15], v[24:27]
    v_mfma_f32_16x16x32_bf16 v[28:31], a[12:15], v[12:15], v[28:31]
    v_permlane32_swap_b32 v32, v36
    v_permlane32_swap_b32 v33, v37
    v_permlane32_swap_b32 v34, v38
    v_permlane32_swap_b32 v35, v39
    v_add_f32_dpp v152, v36, v32 quad_perm:[2,3,2,3] row_mask:0xf bank_mask:0xf
    v_add_f32_dpp v154, v37, v33 quad_perm:[2,3,2,3] row_mask:0xf bank_mask:0xf
    v_add_f32_dpp v156, v38, v34 quad_perm:[2,3,2,3] row_mask:0xf bank_mask:0xf
    v_add_f32_dpp v158, v39, v35 quad_perm:[2,3,2,3] row_mask:0xf bank_mask:0xf
    v_max3_f32 v0, v0, v152, v154
    v_max3_f32 v0, v0, v156, v158
    s_waitcnt vmcnt(5)
    buffer_load_dwordx4 a[40:43], v5, s[28:31], s39 offen offset:384 nt
    s_waitcnt vmcnt(5)
    buffer_load_dwordx4 a[44:47], v5, s[28:31], s92 offen offset:384 nt
    s_waitcnt vmcnt(5)
    s_add_u32 s26, s25, 0x88000
    buffer_load_dwordx4 a[48:51], v5, s[28:31], s26 offen offset:256 nt
    s_waitcnt vmcnt(5)
    s_add_u32 s38, s25, 0xc8000
    buffer_load_dwordx4 a[52:55], v5, s[28:31], s38 offen offset:256 nt
    v_mfma_f32_16x16x32_bf16 v[32:35], a[16:19], v[8:11], 0
    v_mfma_f32_16x16x32_bf16 v[36:39], a[20:23], v[8:11], 0
    v_mfma_f32_16x16x32_bf16 v[32:35], a[24:27], v[12:15], v[32:35]
    v_mfma_f32_16x16x32_bf16 v[36:39], a[28:31], v[12:15], v[36:39]
    v_permlane32_swap_b32 v24, v28
    v_permlane32_swap_b32 v25, v29
    v_permlane32_swap_b32 v26, v30
    v_permlane32_swap_b32 v27, v31
    v_add_f32_dpp v160, v28, v24 quad_perm:[2,3,2,3] row_mask:0xf bank_mask:0xf
    v_add_f32_dpp v162, v29, v25 quad_perm:[2,3,2,3] row_mask:0xf bank_mask:0xf
    v_add_f32_dpp v164, v30, v26 quad_perm:[2,3,2,3] row_mask:0xf bank_mask:0xf
    v_add_f32_dpp v166, v31, v27 quad_perm:[2,3,2,3] row_mask:0xf bank_mask:0xf
    v_max3_f32 v0, v0, v160, v162
    v_max3_f32 v0, v0, v164, v166
    s_waitcnt vmcnt(5)
    buffer_load_dwordx4 a[56:59], v5, s[28:31], s26 offen offset:384 nt
    s_waitcnt vmcnt(5)
    buffer_load_dwordx4 a[60:63], v5, s[28:31], s38 offen offset:384 nt
    s_waitcnt vmcnt(5)
    buffer_load_dwordx4 a[0:3], v5, s[28:31], s25 offen offset:1024 nt
    s_waitcnt vmcnt(5)
    s_add_u32 s39, s25, 0x40000
    buffer_load_dwordx4 a[4:7], v5, s[28:31], s39 offen offset:1024 nt
    v_mfma_f32_16x16x32_bf16 v[24:27], a[32:35], v[8:11], 0
    v_mfma_f32_16x16x32_bf16 v[28:31], a[36:39], v[8:11], 0
    v_mfma_f32_16x16x32_bf16 v[24:27], a[40:43], v[12:15], v[24:27]
    v_mfma_f32_16x16x32_bf16 v[28:31], a[44:47], v[12:15], v[28:31]
    v_permlane32_swap_b32 v32, v36
    v_permlane32_swap_b32 v33, v37
    v_permlane32_swap_b32 v34, v38
    v_permlane32_swap_b32 v35, v39
    v_add_f32_dpp v168, v36, v32 quad_perm:[2,3,2,3] row_mask:0xf bank_mask:0xf
    v_add_f32_dpp v170, v37, v33 quad_perm:[2,3,2,3] row_mask:0xf bank_mask:0xf
    v_add_f32_dpp v172, v38, v34 quad_perm:[2,3,2,3] row_mask:0xf bank_mask:0xf
    v_add_f32_dpp v174, v39, v35 quad_perm:[2,3,2,3] row_mask:0xf bank_mask:0xf
    v_max3_f32 v0, v0, v168, v170
    v_max3_f32 v0, v0, v172, v174
    s_waitcnt vmcnt(5)
    buffer_load_dwordx4 a[8:11], v5, s[28:31], s25 offen offset:1152 nt
    s_waitcnt vmcnt(5)
    buffer_load_dwordx4 a[12:15], v5, s[28:31], s39 offen offset:1152 nt
    s_waitcnt vmcnt(5)
    s_add_u32 s92, s25, 0x80000
    buffer_load_dwordx4 a[16:19], v5, s[28:31], s92 offen offset:1024 nt
    s_waitcnt vmcnt(5)
    s_add_u32 s26, s25, 0xc0000
    buffer_load_dwordx4 a[20:23], v5, s[28:31], s26 offen offset:1024 nt
    v_mfma_f32_16x16x32_bf16 v[32:35], a[48:51], v[8:11], 0
    v_mfma_f32_16x16x32_bf16 v[36:39], a[52:55], v[8:11], 0
    v_mfma_f32_16x16x32_bf16 v[32:35], a[56:59], v[12:15], v[32:35]
    v_mfma_f32_16x16x32_bf16 v[36:39], a[60:63], v[12:15], v[36:39]
    v_permlane32_swap_b32 v24, v28
    v_permlane32_swap_b32 v25, v29
    v_permlane32_swap_b32 v26, v30
    v_permlane32_swap_b32 v27, v31
    v_add_f32_dpp v176, v28, v24 quad_perm:[2,3,2,3] row_mask:0xf bank_mask:0xf
    v_add_f32_dpp v178, v29, v25 quad_perm:[2,3,2,3] row_mask:0xf bank_mask:0xf
    v_add_f32_dpp v180, v30, v26 quad_perm:[2,3,2,3] row_mask:0xf bank_mask:0xf
    v_add_f32_dpp v182, v31, v27 quad_perm:[2,3,2,3] row_mask:0xf bank_mask:0xf
    v_max3_f32 v0, v0, v176, v178
    v_max3_f32 v0, v0, v180, v182
    s_waitcnt vmcnt(5)
    buffer_load_dwordx4 a[24:27], v5, s[28:31], s92 offen offset:1152 nt
    s_waitcnt vmcnt(5)
    buffer_load_dwordx4 a[28:31], v5, s[28:31], s26 offen offset:1152 nt
    s_waitcnt vmcnt(5)
    s_add_u32 s38, s25, 0x8000
    buffer_load_dwordx4 a[32:35], v5, s[28:31], s38 offen offset:1024 nt
    s_waitcnt vmcnt(5)
    s_add_u32 s39, s25, 0x48000
    buffer_load_dwordx4 a[36:39], v5, s[28:31], s39 offen offset:1024 nt
    v_mfma_f32_16x16x32_bf16 v[24:27], a[0:3], v[8:11], 0
    v_mfma_f32_16x16x32_bf16 v[28:31], a[4:7], v[8:11], 0
    v_mfma_f32_16x16x32_bf16 v[24:27], a[8:11], v[12:15], v[24:27]
    v_mfma_f32_16x16x32_bf16 v[28:31], a[12:15], v[12:15], v[28:31]
    v_permlane32_swap_b32 v32, v36
    v_permlane32_swap_b32 v33, v37
    v_permlane32_swap_b32 v34, v38
    v_permlane32_swap_b32 v35, v39
    v_add_f32_dpp v184, v36, v32 quad_perm:[2,3,2,3] row_mask:0xf bank_mask:0xf
    v_add_f32_dpp v186, v37, v33 quad_perm:[2,3,2,3] row_mask:0xf bank_mask:0xf
    v_add_f32_dpp v188, v38, v34 quad_perm:[2,3,2,3] row_mask:0xf bank_mask:0xf
    v_add_f32_dpp v190, v39, v35 quad_perm:[2,3,2,3] row_mask:0xf bank_mask:0xf
    v_max3_f32 v0, v0, v184, v186
    v_max3_f32 v0, v0, v188, v190
    s_waitcnt vmcnt(5)
    buffer_load_dwordx4 a[40:43], v5, s[28:31], s38 offen offset:1152 nt
    s_waitcnt vmcnt(5)
    buffer_load_dwordx4 a[44:47], v5, s[28:31], s39 offen offset:1152 nt
    s_waitcnt vmcnt(5)
    s_add_u32 s92, s25, 0x88000
    buffer_load_dwordx4 a[48:51], v5, s[28:31], s92 offen offset:1024 nt
    s_waitcnt vmcnt(5)
    s_add_u32 s26, s25, 0xc8000
    buffer_load_dwordx4 a[52:55], v5, s[28:31], s26 offen offset:1024 nt
    v_mfma_f32_16x16x32_bf16 v[32:35], a[16:19], v[8:11], 0
    v_mfma_f32_16x16x32_bf16 v[36:39], a[20:23], v[8:11], 0
    v_mfma_f32_16x16x32_bf16 v[32:35], a[24:27], v[12:15], v[32:35]
    v_mfma_f32_16x16x32_bf16 v[36:39], a[28:31], v[12:15], v[36:39]
    v_permlane32_swap_b32 v24, v28
    v_permlane32_swap_b32 v25, v29
    v_permlane32_swap_b32 v26, v30
    v_permlane32_swap_b32 v27, v31
    v_add_f32_dpp v192, v28, v24 quad_perm:[2,3,2,3] row_mask:0xf bank_mask:0xf
    v_add_f32_dpp v194, v29, v25 quad_perm:[2,3,2,3] row_mask:0xf bank_mask:0xf
    v_add_f32_dpp v196, v30, v26 quad_perm:[2,3,2,3] row_mask:0xf bank_mask:0xf
    v_add_f32_dpp v198, v31, v27 quad_perm:[2,3,2,3] row_mask:0xf bank_mask:0xf
    v_max3_f32 v0, v0, v192, v194
    v_max3_f32 v0, v0, v196, v198
    s_waitcnt vmcnt(5)
    buffer_load_dwordx4 a[56:59], v5, s[28:31], s92 offen offset:1152 nt
    s_waitcnt vmcnt(5)
    buffer_load_dwordx4 a[60:63], v5, s[28:31], s26 offen offset:1152 nt
    s_waitcnt vmcnt(5)
    buffer_load_dwordx4 a[0:3], v5, s[28:31], s25 offen offset:1280 nt
    s_waitcnt vmcnt(5)
    s_add_u32 s38, s25, 0x40000
    buffer_load_dwordx4 a[4:7], v5, s[28:31], s38 offen offset:1280 nt
    v_mfma_f32_16x16x32_bf16 v[24:27], a[32:35], v[8:11], 0
    v_mfma_f32_16x16x32_bf16 v[28:31], a[36:39], v[8:11], 0
    v_mfma_f32_16x16x32_bf16 v[24:27], a[40:43], v[12:15], v[24:27]
    v_mfma_f32_16x16x32_bf16 v[28:31], a[44:47], v[12:15], v[28:31]
    v_permlane32_swap_b32 v32, v36
    v_permlane32_swap_b32 v33, v37
    v_permlane32_swap_b32 v34, v38
    v_permlane32_swap_b32 v35, v39
    v_add_f32_dpp v200, v36, v32 quad_perm:[2,3,2,3] row_mask:0xf bank_mask:0xf
    v_add_f32_dpp v202, v37, v33 quad_perm:[2,3,2,3] row_mask:0xf bank_mask:0xf
    v_add_f32_dpp v204, v38, v34 quad_perm:[2,3,2,3] row_mask:0xf bank_mask:0xf
    v_add_f32_dpp v206, v39, v35 quad_perm:[2,3,2,3] row_mask:0xf bank_mask:0xf
    v_max3_f32 v0, v0, v200, v202
    v_max3_f32 v0, v0, v204, v206
    s_waitcnt vmcnt(5)
    buffer_load_dwordx4 a[8:11], v5, s[28:31], s25 offen offset:1408 nt
    s_waitcnt vmcnt(5)
    buffer_load_dwordx4 a[12:15], v5, s[28:31], s38 offen offset:1408 nt
    s_waitcnt vmcnt(5)
    s_add_u32 s39, s25, 0x80000
    buffer_load_dwordx4 a[16:19], v5, s[28:31], s39 offen offset:1280 nt
    s_waitcnt vmcnt(5)
    s_add_u32 s92, s25, 0xc0000
    buffer_load_dwordx4 a[20:23], v5, s[28:31], s92 offen offset:1280 nt
    v_mfma_f32_16x16x32_bf16 v[32:35], a[48:51], v[8:11], 0
    v_mfma_f32_16x16x32_bf16 v[36:39], a[52:55], v[8:11], 0
    v_mfma_f32_16x16x32_bf16 v[32:35], a[56:59], v[12:15], v[32:35]
    v_mfma_f32_16x16x32_bf16 v[36:39], a[60:63], v[12:15], v[36:39]
    v_permlane32_swap_b32 v24, v28
    v_permlane32_swap_b32 v25, v29
    v_permlane32_swap_b32 v26, v30
    v_permlane32_swap_b32 v27, v31
    v_add_f32_dpp v208, v28, v24 quad_perm:[2,3,2,3] row_mask:0xf bank_mask:0xf
    v_add_f32_dpp v210, v29, v25 quad_perm:[2,3,2,3] row_mask:0xf bank_mask:0xf
    v_add_f32_dpp v212, v30, v26 quad_perm:[2,3,2,3] row_mask:0xf bank_mask:0xf
    v_add_f32_dpp v214, v31, v27 quad_perm:[2,3,2,3] row_mask:0xf bank_mask:0xf
    v_max3_f32 v0, v0, v208, v210
    v_max3_f32 v0, v0, v212, v214
    s_waitcnt vmcnt(5)
    buffer_load_dwordx4 a[24:27], v5, s[28:31], s39 offen offset:1408 nt
    s_waitcnt vmcnt(5)
    buffer_load_dwordx4 a[28:31], v5, s[28:31], s92 offen offset:1408 nt
    s_waitcnt vmcnt(5)
    s_add_u32 s26, s25, 0x8000
    buffer_load_dwordx4 a[32:35], v5, s[28:31], s26 offen offset:1280 nt
    s_waitcnt vmcnt(5)
    s_add_u32 s38, s25, 0x48000
    buffer_load_dwordx4 a[36:39], v5, s[28:31], s38 offen offset:1280 nt
    v_mfma_f32_16x16x32_bf16 v[24:27], a[0:3], v[8:11], 0
    v_mfma_f32_16x16x32_bf16 v[28:31], a[4:7], v[8:11], 0
    v_mfma_f32_16x16x32_bf16 v[24:27], a[8:11], v[12:15], v[24:27]
    v_mfma_f32_16x16x32_bf16 v[28:31], a[12:15], v[12:15], v[28:31]
    v_permlane32_swap_b32 v32, v36
    v_permlane32_swap_b32 v33, v37
    v_permlane32_swap_b32 v34, v38
    v_permlane32_swap_b32 v35, v39
    v_add_f32_dpp v216, v36, v32 quad_perm:[2,3,2,3] row_mask:0xf bank_mask:0xf
    v_add_f32_dpp v218, v37, v33 quad_perm:[2,3,2,3] row_mask:0xf bank_mask:0xf
    v_add_f32_dpp v220, v38, v34 quad_perm:[2,3,2,3] row_mask:0xf bank_mask:0xf
    v_add_f32_dpp v222, v39, v35 quad_perm:[2,3,2,3] row_mask:0xf bank_mask:0xf
    v_max3_f32 v0, v0, v216, v218
    v_max3_f32 v0, v0, v220, v222
    s_waitcnt vmcnt(5)
    buffer_load_dwordx4 a[40:43], v5, s[28:31], s26 offen offset:1408 nt
    s_waitcnt vmcnt(5)
    buffer_load_dwordx4 a[44:47], v5, s[28:31], s38 offen offset:1408 nt
    s_waitcnt vmcnt(5)
    s_add_u32 s39, s25, 0x88000
    buffer_load_dwordx4 a[48:51], v5, s[28:31], s39 offen offset:1280 nt
    s_waitcnt vmcnt(5)
    s_add_u32 s92, s25, 0xc8000
    buffer_load_dwordx4 a[52:55], v5, s[28:31], s92 offen offset:1280 nt
    v_mfma_f32_16x16x32_bf16 v[32:35], a[16:19], v[8:11], 0
    v_mfma_f32_16x16x32_bf16 v[36:39], a[20:23], v[8:11], 0
    v_mfma_f32_16x16x32_bf16 v[32:35], a[24:27], v[12:15], v[32:35]
    v_mfma_f32_16x16x32_bf16 v[36:39], a[28:31], v[12:15], v[36:39]
    v_permlane32_swap_b32 v24, v28
    v_permlane32_swap_b32 v25, v29
    v_permlane32_swap_b32 v26, v30
    v_permlane32_swap_b32 v27, v31
    v_add_f32_dpp v224, v28, v24 quad_perm:[2,3,2,3] row_mask:0xf bank_mask:0xf
    v_add_f32_dpp v226, v29, v25 quad_perm:[2,3,2,3] row_mask:0xf bank_mask:0xf
    v_add_f32_dpp v228, v30, v26 quad_perm:[2,3,2,3] row_mask:0xf bank_mask:0xf
    v_add_f32_dpp v230, v31, v27 quad_perm:[2,3,2,3] row_mask:0xf bank_mask:0xf
    v_max3_f32 v0, v0, v224, v226
    v_max3_f32 v0, v0, v228, v230
    s_waitcnt vmcnt(5)
    buffer_load_dwordx4 a[56:59], v5, s[28:31], s39 offen offset:1408 nt
    s_waitcnt vmcnt(5)
    buffer_load_dwordx4 a[60:63], v5, s[28:31], s92 offen offset:1408 nt
    s_waitcnt vmcnt(5)
    buffer_load_dwordx4 a[0:3], v6, s[32:35], s25 offen offset:0 nt
    s_waitcnt vmcnt(5)
    s_add_u32 s26, s25, 0x400000
    buffer_load_dwordx4 a[4:7], v6, s[32:35], s26 offen offset:0 nt
    v_mfma_f32_16x16x32_bf16 v[24:27], a[32:35], v[8:11], 0
    v_mfma_f32_16x16x32_bf16 v[28:31], a[36:39], v[8:11], 0
    v_mfma_f32_16x16x32_bf16 v[24:27], a[40:43], v[12:15], v[24:27]
    v_mfma_f32_16x16x32_bf16 v[28:31], a[44:47], v[12:15], v[28:31]
    v_permlane32_swap_b32 v32, v36
    v_permlane32_swap_b32 v33, v37
    v_permlane32_swap_b32 v34, v38
    v_permlane32_swap_b32 v35, v39
    v_add_f32_dpp v232, v36, v32 quad_perm:[2,3,2,3] row_mask:0xf bank_mask:0xf
    v_add_f32_dpp v234, v37, v33 quad_perm:[2,3,2,3] row_mask:0xf bank_mask:0xf
    v_add_f32_dpp v236, v38, v34 quad_perm:[2,3,2,3] row_mask:0xf bank_mask:0xf
    v_add_f32_dpp v238, v39, v35 quad_perm:[2,3,2,3] row_mask:0xf bank_mask:0xf
    v_max3_f32 v0, v0, v232, v234
    v_max3_f32 v0, v0, v236, v238
    s_waitcnt vmcnt(5)
    buffer_load_dwordx4 a[8:11], v6, s[32:35], s25 offen offset:512 nt
    s_waitcnt vmcnt(5)
    buffer_load_dwordx4 a[12:15], v6, s[32:35], s26 offen offset:512 nt
    s_waitcnt vmcnt(5)
    s_add_u32 s38, s25, 0x80000
    buffer_load_dwordx4 a[16:19], v6, s[32:35], s38 offen offset:0 nt
    s_waitcnt vmcnt(5)
    s_add_u32 s39, s25, 0x480000
    buffer_load_dwordx4 a[20:23], v6, s[32:35], s39 offen offset:0 nt
    v_mfma_f32_16x16x32_bf16 v[32:35], a[48:51], v[8:11], 0
    v_mfma_f32_16x16x32_bf16 v[36:39], a[52:55], v[8:11], 0
    v_mfma_f32_16x16x32_bf16 v[32:35], a[56:59], v[12:15], v[32:35]
    v_mfma_f32_16x16x32_bf16 v[36:39], a[60:63], v[12:15], v[36:39]
    v_permlane32_swap_b32 v24, v28
    v_permlane32_swap_b32 v25, v29
    v_permlane32_swap_b32 v26, v30
    v_permlane32_swap_b32 v27, v31
    v_add_f32_dpp v240, v28, v24 quad_perm:[2,3,2,3] row_mask:0xf bank_mask:0xf
    v_add_f32_dpp v242, v29, v25 quad_perm:[2,3,2,3] row_mask:0xf bank_mask:0xf
    v_add_f32_dpp v244, v30, v26 quad_perm:[2,3,2,3] row_mask:0xf bank_mask:0xf
    v_add_f32_dpp v246, v31, v27 quad_perm:[2,3,2,3] row_mask:0xf bank_mask:0xf
    v_max3_f32 v0, v0, v240, v242
    v_max3_f32 v0, v0, v244, v246
    s_waitcnt vmcnt(5)
    buffer_load_dwordx4 a[24:27], v6, s[32:35], s38 offen offset:512 nt
    v_permlane32_swap_b32 v32, v36
    v_permlane32_swap_b32 v33, v37
    v_permlane32_swap_b32 v34, v38
    v_permlane32_swap_b32 v35, v39
    v_add_f32_dpp v248, v36, v32 quad_perm:[2,3,2,3] row_mask:0xf bank_mask:0xf
    v_add_f32_dpp v250, v37, v33 quad_perm:[2,3,2,3] row_mask:0xf bank_mask:0xf
    v_add_f32_dpp v252, v38, v34 quad_perm:[2,3,2,3] row_mask:0xf bank_mask:0xf
    v_add_f32_dpp v254, v39, v35 quad_perm:[2,3,2,3] row_mask:0xf bank_mask:0xf
    v_max3_f32 v0, v0, v248, v250
    v_max3_f32 v0, v0, v252, v254
    v_mov_b32 v5, v0
    v_mov_b32 v40, 0
    v_mov_b32 v41, 0
    v_permlane16_swap_b32 v0, v5
    v_max_f32 v0, v0, v5
    v_mov_b32 v5, v0
    v_mov_b32 v42, 0
    v_mov_b32 v43, 0
    v_permlane32_swap_b32 v0, v5
    v_max_f32 v0, v0, v5
    v_mul_f32 v0, s40, v0
    v_mov_b32 v44, 0
    v_mov_b32 v45, 0
    v_mov_b32 v46, 0
    v_mov_b32 v47, 0
    v_mov_b32 v5, 0
    s_mov_b64 exec, 0x1111
    ds_write_b32 v124, v0 offset:9216
    s_mov_b64 exec, -1
    s_waitcnt vmcnt(5)
    buffer_load_dwordx4 a[28:31], v6, s[32:35], s39 offen offset:512 nt
    v_fma_f32 v128, v128, s40, -v0
    v_fma_f32 v130, v130, s40, -v0
    v_fma_f32 v132, v132, s40, -v0
    v_fma_f32 v134, v134, s40, -v0
    v_exp_f32_dpp v128, v128 quad_perm:[0,1,0,1] row_mask:0xf bank_mask:0xf
    v_exp_f32_dpp v130, v130 quad_perm:[0,1,0,1] row_mask:0xf bank_mask:0xf
    v_exp_f32_dpp v132, v132 quad_perm:[0,1,0,1] row_mask:0xf bank_mask:0xf
    v_exp_f32_dpp v134, v134 quad_perm:[0,1,0,1] row_mask:0xf bank_mask:0xf
    v_cvt_pk_bf16_f32 v24, v128, v128
    v_cvt_pk_bf16_f32 v25, v130, v130
    v_cvt_pk_bf16_f32 v26, v132, v132
    v_cvt_pk_bf16_f32 v27, v134, v134
    v_add_f32 v28, v128, v130
    v_add_f32 v29, v132, v134
    v_and_b32 v128, v24, v2
    v_and_b32 v129, v24, v7
    v_and_b32 v130, v25, v2
    v_and_b32 v131, v25, v7
    v_and_b32 v132, v26, v2
    v_and_b32 v133, v26, v7
    v_and_b32 v134, v27, v2
    v_and_b32 v135, v27, v7
    v_add_f32 v28, v28, v29
    v_add_f32 v5, v5, v28
    v_mfma_f32_16x16x16_bf16 v[40:43], v[128:129], a[0:1], v[40:43]
    v_mfma_f32_16x16x16_bf16 v[44:47], v[128:129], a[2:3], v[44:47]
    v_mfma_f32_16x16x16_bf16 v[40:43], v[130:131], a[4:5], v[40:43]
    v_mfma_f32_16x16x16_bf16 v[44:47], v[130:131], a[6:7], v[44:47]
    s_waitcnt vmcnt(5)
    s_add_u32 s92, s25, 0x8000
    buffer_load_dwordx4 a[32:35], v6, s[32:35], s92 offen offset:0 nt
    v_fma_f32 v136, v136, s40, -v0
    v_fma_f32 v138, v138, s40, -v0
    v_fma_f32 v140, v140, s40, -v0
    v_fma_f32 v142, v142, s40, -v0
    v_exp_f32_dpp v136, v136 quad_perm:[0,1,0,1] row_mask:0xf bank_mask:0xf
    v_exp_f32_dpp v138, v138 quad_perm:[0,1,0,1] row_mask:0xf bank_mask:0xf
    v_exp_f32_dpp v140, v140 quad_perm:[0,1,0,1] row_mask:0xf bank_mask:0xf
    v_exp_f32_dpp v142, v142 quad_perm:[0,1,0,1] row_mask:0xf bank_mask:0xf
    v_cvt_pk_bf16_f32 v24, v136, v136
    v_cvt_pk_bf16_f32 v25, v138, v138
    v_cvt_pk_bf16_f32 v26, v140, v140
    v_cvt_pk_bf16_f32 v27, v142, v142
    v_add_f32 v28, v136, v138
    v_add_f32 v29, v140, v142
    v_and_b32 v136, v24, v2
    v_and_b32 v137, v24, v7
    v_and_b32 v138, v25, v2
    v_and_b32 v139, v25, v7
    v_and_b32 v140, v26, v2
    v_and_b32 v141, v26, v7
    v_and_b32 v142, v27, v2
    v_and_b32 v143, v27, v7
    v_add_f32 v28, v28, v29
    v_add_f32 v5, v5, v28
    v_mfma_f32_16x16x16_bf16 v[40:43], v[132:133], a[8:9], v[40:43]
    v_mfma_f32_16x16x16_bf16 v[44:47], v[132:133], a[10:11], v[44:47]
    s_waitcnt vmcnt(5)
    s_add_u32 s26, s25, 0x408000
    buffer_load_dwordx4 a[36:39], v6, s[32:35], s26 offen offset:0 nt
    v_fma_f32 v144, v144, s40, -v0
    v_fma_f32 v146, v146, s40, -v0
    v_fma_f32 v148, v148, s40, -v0
    v_fma_f32 v150, v150, s40, -v0
    v_exp_f32_dpp v144, v144 quad_perm:[0,1,0,1] row_mask:0xf bank_mask:0xf
    v_exp_f32_dpp v146, v146 quad_perm:[0,1,0,1] row_mask:0xf bank_mask:0xf
    v_exp_f32_dpp v148, v148 quad_perm:[0,1,0,1] row_mask:0xf bank_mask:0xf
    v_exp_f32_dpp v150, v150 quad_perm:[0,1,0,1] row_mask:0xf bank_mask:0xf
    v_cvt_pk_bf16_f32 v24, v144, v144
    v_cvt_pk_bf16_f32 v25, v146, v146
    v_cvt_pk_bf16_f32 v26, v148, v148
    v_cvt_pk_bf16_f32 v27, v150, v150
    v_add_f32 v28, v144, v146
    v_add_f32 v29, v148, v150
    v_and_b32 v144, v24, v2
    v_and_b32 v145, v24, v7
    v_and_b32 v146, v25, v2
    v_and_b32 v147, v25, v7
    v_and_b32 v148, v26, v2
    v_and_b32 v149, v26, v7
    v_and_b32 v150, v27, v2
    v_and_b32 v151, v27, v7
    v_add_f32 v28, v28, v29
    v_add_f32 v5, v5, v28
    v_mfma_f32_16x16x16_bf16 v[40:43], v[134:135], a[12:13], v[40:43]
    v_mfma_f32_16x16x16_bf16 v[44:47], v[134:135], a[14:15], v[44:47]
    s_waitcnt vmcnt(5)
    buffer_load_dwordx4 a[40:43], v6, s[32:35], s92 offen offset:512 nt
    v_fma_f32 v152, v152, s40, -v0
    v_fma_f32 v154, v154, s40, -v0
    v_fma_f32 v156, v156, s40, -v0
    v_fma_f32 v158, v158, s40, -v0
    v_exp_f32_dpp v152, v152 quad_perm:[0,1,0,1] row_mask:0xf bank_mask:0xf
    v_exp_f32_dpp v154, v154 quad_perm:[0,1,0,1] row_mask:0xf bank_mask:0xf
    v_exp_f32_dpp v156, v156 quad_perm:[0,1,0,1] row_mask:0xf bank_mask:0xf
    v_exp_f32_dpp v158, v158 quad_perm:[0,1,0,1] row_mask:0xf bank_mask:0xf
    v_cvt_pk_bf16_f32 v24, v152, v152
    v_cvt_pk_bf16_f32 v25, v154, v154
    v_cvt_pk_bf16_f32 v26, v156, v156
    v_cvt_pk_bf16_f32 v27, v158, v158
    v_add_f32 v28, v152, v154
    v_add_f32 v29, v156, v158
    v_and_b32 v152, v24, v2
    v_and_b32 v153, v24, v7
    v_and_b32 v154, v25, v2
    v_and_b32 v155, v25, v7
    v_and_b32 v156, v26, v2
    v_and_b32 v157, v26, v7
    v_and_b32 v158, v27, v2
    v_and_b32 v159, v27, v7
    v_add_f32 v28, v28, v29
    v_add_f32 v5, v5, v28
    v_mfma_f32_16x16x16_bf16 v[40:43], v[136:137], a[16:17], v[40:43]
    v_mfma_f32_16x16x16_bf16 v[44:47], v[136:137], a[18:19], v[44:47]
    s_waitcnt vmcnt(5)
    buffer_load_dwordx4 a[44:47], v6, s[32:35], s26 offen offset:512 nt
    v_fma_f32 v160, v160, s40, -v0
    v_fma_f32 v162, v162, s40, -v0
    v_fma_f32 v164, v164, s40, -v0
    v_fma_f32 v166, v166, s40, -v0
    v_exp_f32_dpp v160, v160 quad_perm:[0,1,0,1] row_mask:0xf bank_mask:0xf
    v_exp_f32_dpp v162, v162 quad_perm:[0,1,0,1] row_mask:0xf bank_mask:0xf
    v_exp_f32_dpp v164, v164 quad_perm:[0,1,0,1] row_mask:0xf bank_mask:0xf
    v_exp_f32_dpp v166, v166 quad_perm:[0,1,0,1] row_mask:0xf bank_mask:0xf
    v_cvt_pk_bf16_f32 v24, v160, v160
    v_cvt_pk_bf16_f32 v25, v162, v162
    v_cvt_pk_bf16_f32 v26, v164, v164
    v_cvt_pk_bf16_f32 v27, v166, v166
    v_add_f32 v28, v160, v162
    v_add_f32 v29, v164, v166
    v_and_b32 v160, v24, v2
    v_and_b32 v161, v24, v7
    v_and_b32 v162, v25, v2
    v_and_b32 v163, v25, v7
    v_and_b32 v164, v26, v2
    v_and_b32 v165, v26, v7
    v_and_b32 v166, v27, v2
    v_and_b32 v167, v27, v7
    v_add_f32 v28, v28, v29
    v_add_f32 v5, v5, v28
    v_mfma_f32_16x16x16_bf16 v[40:43], v[138:139], a[20:21], v[40:43]
    v_mfma_f32_16x16x16_bf16 v[44:47], v[138:139], a[22:23], v[44:47]
    s_waitcnt vmcnt(5)
    s_add_u32 s38, s25, 0x88000
    buffer_load_dwordx4 a[48:51], v6, s[32:35], s38 offen offset:0 nt
    v_fma_f32 v168, v168, s40, -v0
    v_fma_f32 v170, v170, s40, -v0
    v_fma_f32 v172, v172, s40, -v0
    v_fma_f32 v174, v174, s40, -v0
    v_exp_f32_dpp v168, v168 quad_perm:[0,1,0,1] row_mask:0xf bank_mask:0xf
    v_exp_f32_dpp v170, v170 quad_perm:[0,1,0,1] row_mask:0xf bank_mask:0xf
    v_exp_f32_dpp v172, v172 quad_perm:[0,1,0,1] row_mask:0xf bank_mask:0xf
    v_exp_f32_dpp v174, v174 quad_perm:[0,1,0,1] row_mask:0xf bank_mask:0xf
    v_cvt_pk_bf16_f32 v24, v168, v168
    v_cvt_pk_bf16_f32 v25, v170, v170
    v_cvt_pk_bf16_f32 v26, v172, v172
    v_cvt_pk_bf16_f32 v27, v174, v174
    v_add_f32 v28, v168, v170
    v_add_f32 v29, v172, v174
    v_and_b32 v168, v24, v2
    v_and_b32 v169, v24, v7
    v_and_b32 v170, v25, v2
    v_and_b32 v171, v25, v7
    v_and_b32 v172, v26, v2
    v_and_b32 v173, v26, v7
    v_and_b32 v174, v27, v2
    v_and_b32 v175, v27, v7
    v_add_f32 v28, v28, v29
    v_add_f32 v5, v5, v28
    v_mfma_f32_16x16x16_bf16 v[40:43], v[140:141], a[24:25], v[40:43]
    v_mfma_f32_16x16x16_bf16 v[44:47], v[140:141], a[26:27], v[44:47]
    s_waitcnt vmcnt(5)
    s_add_u32 s39, s25, 0x488000
    buffer_load_dwordx4 a[52:55], v6, s[32:35], s39 offen offset:0 nt
    v_fma_f32 v176, v176, s40, -v0
    v_fma_f32 v178, v178, s40, -v0
    v_fma_f32 v180, v180, s40, -v0
    v_fma_f32 v182, v182, s40, -v0
    v_exp_f32_dpp v176, v176 quad_perm:[0,1,0,1] row_mask:0xf bank_mask:0xf
    v_exp_f32_dpp v178, v178 quad_perm:[0,1,0,1] row_mask:0xf bank_mask:0xf
    v_exp_f32_dpp v180, v180 quad_perm:[0,1,0,1] row_mask:0xf bank_mask:0xf
    v_exp_f32_dpp v182, v182 quad_perm:[0,1,0,1] row_mask:0xf bank_mask:0xf
    v_cvt_pk_bf16_f32 v24, v176, v176
    v_cvt_pk_bf16_f32 v25, v178, v178
    v_cvt_pk_bf16_f32 v26, v180, v180
    v_cvt_pk_bf16_f32 v27, v182, v182
    v_add_f32 v28, v176, v178
    v_add_f32 v29, v180, v182
    v_and_b32 v176, v24, v2
    v_and_b32 v177, v24, v7
    v_and_b32 v178, v25, v2
    v_and_b32 v179, v25, v7
    v_and_b32 v180, v26, v2
    v_and_b32 v181, v26, v7
    v_and_b32 v182, v27, v2
    v_and_b32 v183, v27, v7
    v_add_f32 v28, v28, v29
    v_add_f32 v5, v5, v28
    v_mfma_f32_16x16x16_bf16 v[40:43], v[142:143], a[28:29], v[40:43]
    v_mfma_f32_16x16x16_bf16 v[44:47], v[142:143], a[30:31], v[44:47]
    s_waitcnt vmcnt(5)
    buffer_load_dwordx4 a[56:59], v6, s[32:35], s38 offen offset:512 nt
    v_fma_f32 v184, v184, s40, -v0
    v_fma_f32 v186, v186, s40, -v0
    v_fma_f32 v188, v188, s40, -v0
    v_fma_f32 v190, v190, s40, -v0
    v_exp_f32_dpp v184, v184 quad_perm:[0,1,0,1] row_mask:0xf bank_mask:0xf
    v_exp_f32_dpp v186, v186 quad_perm:[0,1,0,1] row_mask:0xf bank_mask:0xf
    v_exp_f32_dpp v188, v188 quad_perm:[0,1,0,1] row_mask:0xf bank_mask:0xf
    v_exp_f32_dpp v190, v190 quad_perm:[0,1,0,1] row_mask:0xf bank_mask:0xf
    v_cvt_pk_bf16_f32 v24, v184, v184
    v_cvt_pk_bf16_f32 v25, v186, v186
    v_cvt_pk_bf16_f32 v26, v188, v188
    v_cvt_pk_bf16_f32 v27, v190, v190
    v_add_f32 v28, v184, v186
    v_add_f32 v29, v188, v190
    v_and_b32 v184, v24, v2
    v_and_b32 v185, v24, v7
    v_and_b32 v186, v25, v2
    v_and_b32 v187, v25, v7
    v_and_b32 v188, v26, v2
    v_and_b32 v189, v26, v7
    v_and_b32 v190, v27, v2
    v_and_b32 v191, v27, v7
    v_add_f32 v28, v28, v29
    v_add_f32 v5, v5, v28
    v_mfma_f32_16x16x16_bf16 v[40:43], v[144:145], a[32:33], v[40:43]
    v_mfma_f32_16x16x16_bf16 v[44:47], v[144:145], a[34:35], v[44:47]
    s_waitcnt vmcnt(5)
    buffer_load_dwordx4 a[60:63], v6, s[32:35], s39 offen offset:512 nt
    v_fma_f32 v192, v192, s40, -v0
    v_fma_f32 v194, v194, s40, -v0
    v_fma_f32 v196, v196, s40, -v0
    v_fma_f32 v198, v198, s40, -v0
    v_exp_f32_dpp v192, v192 quad_perm:[0,1,0,1] row_mask:0xf bank_mask:0xf
    v_exp_f32_dpp v194, v194 quad_perm:[0,1,0,1] row_mask:0xf bank_mask:0xf
    v_exp_f32_dpp v196, v196 quad_perm:[0,1,0,1] row_mask:0xf bank_mask:0xf
    v_exp_f32_dpp v198, v198 quad_perm:[0,1,0,1] row_mask:0xf bank_mask:0xf
    v_cvt_pk_bf16_f32 v24, v192, v192
    v_cvt_pk_bf16_f32 v25, v194, v194
    v_cvt_pk_bf16_f32 v26, v196, v196
    v_cvt_pk_bf16_f32 v27, v198, v198
    v_add_f32 v28, v192, v194
    v_add_f32 v29, v196, v198
    v_and_b32 v192, v24, v2
    v_and_b32 v193, v24, v7
    v_and_b32 v194, v25, v2
    v_and_b32 v195, v25, v7
    v_and_b32 v196, v26, v2
    v_and_b32 v197, v26, v7
    v_and_b32 v198, v27, v2
    v_and_b32 v199, v27, v7
    v_add_f32 v28, v28, v29
    v_add_f32 v5, v5, v28
    v_mfma_f32_16x16x16_bf16 v[40:43], v[146:147], a[36:37], v[40:43]
    v_mfma_f32_16x16x16_bf16 v[44:47], v[146:147], a[38:39], v[44:47]
    s_waitcnt vmcnt(5)
    buffer_load_dwordx4 a[0:3], v6, s[32:35], s25 offen offset:256 nt
    v_fma_f32 v200, v200, s40, -v0
    v_fma_f32 v202, v202, s40, -v0
    v_fma_f32 v204, v204, s40, -v0
    v_fma_f32 v206, v206, s40, -v0
    v_exp_f32_dpp v200, v200 quad_perm:[0,1,0,1] row_mask:0xf bank_mask:0xf
    v_exp_f32_dpp v202, v202 quad_perm:[0,1,0,1] row_mask:0xf bank_mask:0xf
    v_exp_f32_dpp v204, v204 quad_perm:[0,1,0,1] row_mask:0xf bank_mask:0xf
    v_exp_f32_dpp v206, v206 quad_perm:[0,1,0,1] row_mask:0xf bank_mask:0xf
    v_cvt_pk_bf16_f32 v24, v200, v200
    v_cvt_pk_bf16_f32 v25, v202, v202
    v_cvt_pk_bf16_f32 v26, v204, v204
    v_cvt_pk_bf16_f32 v27, v206, v206
    v_add_f32 v28, v200, v202
    v_add_f32 v29, v204, v206
    v_and_b32 v200, v24, v2
    v_and_b32 v201, v24, v7
    v_and_b32 v202, v25, v2
    v_and_b32 v203, v25, v7
    v_and_b32 v204, v26, v2
    v_and_b32 v205, v26, v7
    v_and_b32 v206, v27, v2
    v_and_b32 v207, v27, v7
    v_add_f32 v28, v28, v29
    v_add_f32 v5, v5, v28
    v_mfma_f32_16x16x16_bf16 v[40:43], v[148:149], a[40:41], v[40:43]
    v_mfma_f32_16x16x16_bf16 v[44:47], v[148:149], a[42:43], v[44:47]
    s_waitcnt vmcnt(5)
    s_add_u32 s92, s25, 0x400000
    buffer_load_dwordx4 a[4:7], v6, s[32:35], s92 offen offset:256 nt
    v_fma_f32 v208, v208, s40, -v0
    v_fma_f32 v210, v210, s40, -v0
    v_fma_f32 v212, v212, s40, -v0
    v_fma_f32 v214, v214, s40, -v0
    v_exp_f32_dpp v208, v208 quad_perm:[0,1,0,1] row_mask:0xf bank_mask:0xf
    v_exp_f32_dpp v210, v210 quad_perm:[0,1,0,1] row_mask:0xf bank_mask:0xf
    v_exp_f32_dpp v212, v212 quad_perm:[0,1,0,1] row_mask:0xf bank_mask:0xf
    v_exp_f32_dpp v214, v214 quad_perm:[0,1,0,1] row_mask:0xf bank_mask:0xf
    v_cvt_pk_bf16_f32 v24, v208, v208
    v_cvt_pk_bf16_f32 v25, v210, v210
    v_cvt_pk_bf16_f32 v26, v212, v212
    v_cvt_pk_bf16_f32 v27, v214, v214
    v_add_f32 v28, v208, v210
    v_add_f32 v29, v212, v214
    v_and_b32 v208, v24, v2
    v_and_b32 v209, v24, v7
    v_and_b32 v210, v25, v2
    v_and_b32 v211, v25, v7
    v_and_b32 v212, v26, v2
    v_and_b32 v213, v26, v7
    v_and_b32 v214, v27, v2
    v_and_b32 v215, v27, v7
    v_add_f32 v28, v28, v29
    v_add_f32 v5, v5, v28
    v_mfma_f32_16x16x16_bf16 v[40:43], v[150:151], a[44:45], v[40:43]
    v_mfma_f32_16x16x16_bf16 v[44:47], v[150:151], a[46:47], v[44:47]
    s_waitcnt vmcnt(5)
    buffer_load_dwordx4 a[8:11], v6, s[32:35], s25 offen offset:768 nt
    v_fma_f32 v216, v216, s40, -v0
    v_fma_f32 v218, v218, s40, -v0
    v_fma_f32 v220, v220, s40, -v0
    v_fma_f32 v222, v222, s40, -v0
    v_exp_f32_dpp v216, v216 quad_perm:[0,1,0,1] row_mask:0xf bank_mask:0xf
    v_exp_f32_dpp v218, v218 quad_perm:[0,1,0,1] row_mask:0xf bank_mask:0xf
    v_exp_f32_dpp v220, v220 quad_perm:[0,1,0,1] row_mask:0xf bank_mask:0xf
    v_exp_f32_dpp v222, v222 quad_perm:[0,1,0,1] row_mask:0xf bank_mask:0xf
    v_cvt_pk_bf16_f32 v24, v216, v216
    v_cvt_pk_bf16_f32 v25, v218, v218
    v_cvt_pk_bf16_f32 v26, v220, v220
    v_cvt_pk_bf16_f32 v27, v222, v222
    v_add_f32 v28, v216, v218
    v_add_f32 v29, v220, v222
    v_and_b32 v216, v24, v2
    v_and_b32 v217, v24, v7
    v_and_b32 v218, v25, v2
    v_and_b32 v219, v25, v7
    v_and_b32 v220, v26, v2
    v_and_b32 v221, v26, v7
    v_and_b32 v222, v27, v2
    v_and_b32 v223, v27, v7
    v_add_f32 v28, v28, v29
    v_add_f32 v5, v5, v28
    v_mfma_f32_16x16x16_bf16 v[40:43], v[152:153], a[48:49], v[40:43]
    v_mfma_f32_16x16x16_bf16 v[44:47], v[152:153], a[50:51], v[44:47]
    s_waitcnt vmcnt(5)
    buffer_load_dwordx4 a[12:15], v6, s[32:35], s92 offen offset:768 nt
    v_fma_f32 v224, v224, s40, -v0
    v_fma_f32 v226, v226, s40, -v0
    v_fma_f32 v228, v228, s40, -v0
    v_fma_f32 v230, v230, s40, -v0
    v_exp_f32_dpp v224, v224 quad_perm:[0,1,0,1] row_mask:0xf bank_mask:0xf
    v_exp_f32_dpp v226, v226 quad_perm:[0,1,0,1] row_mask:0xf bank_mask:0xf
    v_exp_f32_dpp v228, v228 quad_perm:[0,1,0,1] row_mask:0xf bank_mask:0xf
    v_exp_f32_dpp v230, v230 quad_perm:[0,1,0,1] row_mask:0xf bank_mask:0xf
    v_cvt_pk_bf16_f32 v24, v224, v224
    v_cvt_pk_bf16_f32 v25, v226, v226
    v_cvt_pk_bf16_f32 v26, v228, v228
    v_cvt_pk_bf16_f32 v27, v230, v230
    v_add_f32 v28, v224, v226
    v_add_f32 v29, v228, v230
    v_and_b32 v224, v24, v2
    v_and_b32 v225, v24, v7
    v_and_b32 v226, v25, v2
    v_and_b32 v227, v25, v7
    v_and_b32 v228, v26, v2
    v_and_b32 v229, v26, v7
    v_and_b32 v230, v27, v2
    v_and_b32 v231, v27, v7
    v_add_f32 v28, v28, v29
    v_add_f32 v5, v5, v28
    v_mfma_f32_16x16x16_bf16 v[40:43], v[154:155], a[52:53], v[40:43]
    v_mfma_f32_16x16x16_bf16 v[44:47], v[154:155], a[54:55], v[44:47]
    s_waitcnt vmcnt(5)
    s_add_u32 s26, s25, 0x80000
    buffer_load_dwordx4 a[16:19], v6, s[32:35], s26 offen offset:256 nt
    v_fma_f32 v232, v232, s40, -v0
    v_fma_f32 v234, v234, s40, -v0
    v_fma_f32 v236, v236, s40, -v0
    v_fma_f32 v238, v238, s40, -v0
    v_exp_f32_dpp v232, v232 quad_perm:[0,1,0,1] row_mask:0xf bank_mask:0xf
    v_exp_f32_dpp v234, v234 quad_perm:[0,1,0,1] row_mask:0xf bank_mask:0xf
    v_exp_f32_dpp v236, v236 quad_perm:[0,1,0,1] row_mask:0xf bank_mask:0xf
    v_exp_f32_dpp v238, v238 quad_perm:[0,1,0,1] row_mask:0xf bank_mask:0xf
    v_cvt_pk_bf16_f32 v24, v232, v232
    v_cvt_pk_bf16_f32 v25, v234, v234
    v_cvt_pk_bf16_f32 v26, v236, v236
    v_cvt_pk_bf16_f32 v27, v238, v238
    v_add_f32 v28, v232, v234
    v_add_f32 v29, v236, v238
    v_and_b32 v232, v24, v2
    v_and_b32 v233, v24, v7
    v_and_b32 v234, v25, v2
    v_and_b32 v235, v25, v7
    v_and_b32 v236, v26, v2
    v_and_b32 v237, v26, v7
    v_and_b32 v238, v27, v2
    v_and_b32 v239, v27, v7
    v_add_f32 v28, v28, v29
    v_add_f32 v5, v5, v28
    v_mfma_f32_16x16x16_bf16 v[40:43], v[156:157], a[56:57], v[40:43]
    v_mfma_f32_16x16x16_bf16 v[44:47], v[156:157], a[58:59], v[44:47]
    s_waitcnt vmcnt(5)
    s_add_u32 s38, s25, 0x480000
    buffer_load_dwordx4 a[20:23], v6, s[32:35], s38 offen offset:256 nt
    v_fma_f32 v240, v240, s40, -v0
    v_fma_f32 v242, v242, s40, -v0
    v_fma_f32 v244, v244, s40, -v0
    v_fma_f32 v246, v246, s40, -v0
    v_exp_f32_dpp v240, v240 quad_perm:[0,1,0,1] row_mask:0xf bank_mask:0xf
    v_exp_f32_dpp v242, v242 quad_perm:[0,1,0,1] row_mask:0xf bank_mask:0xf
    v_exp_f32_dpp v244, v244 quad_perm:[0,1,0,1] row_mask:0xf bank_mask:0xf
    v_exp_f32_dpp v246, v246 quad_perm:[0,1,0,1] row_mask:0xf bank_mask:0xf
    v_cvt_pk_bf16_f32 v24, v240, v240
    v_cvt_pk_bf16_f32 v25, v242, v242
    v_cvt_pk_bf16_f32 v26, v244, v244
    v_cvt_pk_bf16_f32 v27, v246, v246
    v_add_f32 v28, v240, v242
    v_add_f32 v29, v244, v246
    v_and_b32 v240, v24, v2
    v_and_b32 v241, v24, v7
    v_and_b32 v242, v25, v2
    v_and_b32 v243, v25, v7
    v_and_b32 v244, v26, v2
    v_and_b32 v245, v26, v7
    v_and_b32 v246, v27, v2
    v_and_b32 v247, v27, v7
    v_add_f32 v28, v28, v29
    v_add_f32 v5, v5, v28
    v_mfma_f32_16x16x16_bf16 v[40:43], v[158:159], a[60:61], v[40:43]
    v_mfma_f32_16x16x16_bf16 v[44:47], v[158:159], a[62:63], v[44:47]
    s_waitcnt vmcnt(5)
    buffer_load_dwordx4 a[24:27], v6, s[32:35], s26 offen offset:768 nt
    v_fma_f32 v248, v248, s40, -v0
    v_fma_f32 v250, v250, s40, -v0
    v_fma_f32 v252, v252, s40, -v0
    v_fma_f32 v254, v254, s40, -v0
    v_exp_f32_dpp v248, v248 quad_perm:[0,1,0,1] row_mask:0xf bank_mask:0xf
    v_exp_f32_dpp v250, v250 quad_perm:[0,1,0,1] row_mask:0xf bank_mask:0xf
    v_exp_f32_dpp v252, v252 quad_perm:[0,1,0,1] row_mask:0xf bank_mask:0xf
    v_exp_f32_dpp v254, v254 quad_perm:[0,1,0,1] row_mask:0xf bank_mask:0xf
    v_cvt_pk_bf16_f32 v24, v248, v248
    v_cvt_pk_bf16_f32 v25, v250, v250
    v_cvt_pk_bf16_f32 v26, v252, v252
    v_cvt_pk_bf16_f32 v27, v254, v254
    v_add_f32 v28, v248, v250
    v_add_f32 v29, v252, v254
    v_and_b32 v248, v24, v2
    v_and_b32 v249, v24, v7
    v_and_b32 v250, v25, v2
    v_and_b32 v251, v25, v7
    v_and_b32 v252, v26, v2
    v_and_b32 v253, v26, v7
    v_and_b32 v254, v27, v2
    v_and_b32 v255, v27, v7
    v_add_f32 v28, v28, v29
    v_add_f32 v5, v5, v28
    global_load_dwordx2 v[20:21], v20, s[18:19] sc1
    s_lshl_b32 s27, s22, 2
    v_mov_b32 v86, s27
    global_load_dword v86, v86, s[18:19] offset:64 sc1
    v_mfma_f32_16x16x16_bf16 v[40:43], v[160:161], a[0:1], v[40:43]
    v_mfma_f32_16x16x16_bf16 v[44:47], v[160:161], a[2:3], v[44:47]
    s_waitcnt vmcnt(7)
    buffer_load_dwordx4 a[28:31], v6, s[32:35], s38 offen offset:768 nt
    v_mov_b32 v0, v5
    s_mul_i32 s27, s24, 2304
    v_lshl_add_u32 v10, v1, 4, s27
    v_permlane16_swap_b32 v5, v0
    v_add_f32 v5, v5, v0
    v_mov_b32 v0, v5
    v_bfe_u32 v11, v1, 1, 1
    v_mul_u32_u24 v11, 1152, v11
    v_permlane32_swap_b32 v5, v0
    v_add_f32 v5, v5, v0
    s_mov_b64 exec, 0x1111
    ds_write_b32 v124, v5 offset:9280
    s_mov_b64 exec, -1
    v_lshrrev_b32 v0, 2, v1
    v_lshl_add_u32 v11, v0, 4, v11
    v_and_b32 v0, 1, v1
    v_lshl_add_u32 v11, v0, 3, v11
    s_lshl_b32 s27, s24, 8
    v_add_u32 v11, s27, v11
    s_lshl_b32 s36, s22, 2
    s_add_u32 s36, s36, s24
    s_lshl_b32 s27, s36, 14
    s_lshl_b32 s37, s23, 6
    s_add_u32 s27, s27, s37
    v_lshrrev_b32 v0, 3, v1
    v_lshl_add_u32 v14, v0, 11, s27
    v_and_b32 v0, 7, v1
    v_lshl_add_u32 v14, v0, 3, v14
    s_lshl_b32 s27, s36, 9
    s_lshl_b32 s37, s23, 4
    s_add_u32 s27, s27, s37
    s_add_u32 s27, s27, 0x80000
    v_mov_b32 v15, s27
    s_lshl_b32 s27, s42, 6
    s_lshl_b32 s37, s56, 6
    s_add_u32 s27, s27, s37
    v_lshl_add_u32 v16, v1, 4, s27
    s_lshl_b32 s27, s42, 1
    s_add_u32 s27, s27, 0x80000
    v_lshrrev_b32 v0, 2, v1
    v_lshl_add_u32 v12, v0, 4, s27
    v_and_b32 v0, 1, v1
    v_lshl_add_u32 v12, v0, 8, v12
    v_add_u32 v23, s42, v23
    s_mov_b32 s50, 0xfffff800
    s_movk_i32 s44, 0x7ff
    s_add_u32 s86, s20, 0x100000
    s_addc_u32 s87, s21, 0
    s_lshl_b32 s27, s24, 4
    v_mov_b32 v13, s27
    v_mfma_f32_16x16x16_bf16 v[40:43], v[162:163], a[4:5], v[40:43]
    v_mfma_f32_16x16x16_bf16 v[44:47], v[162:163], a[6:7], v[44:47]
    s_waitcnt vmcnt(7)
    s_add_u32 s39, s25, 0x8000
    buffer_load_dwordx4 a[32:35], v6, s[32:35], s39 offen offset:256 nt
    v_mfma_f32_16x16x16_bf16 v[40:43], v[164:165], a[8:9], v[40:43]
    v_mfma_f32_16x16x16_bf16 v[44:47], v[164:165], a[10:11], v[44:47]
    s_waitcnt vmcnt(7)
    s_add_u32 s92, s25, 0x408000
    buffer_load_dwordx4 a[36:39], v6, s[32:35], s92 offen offset:256 nt
    v_mfma_f32_16x16x16_bf16 v[40:43], v[166:167], a[12:13], v[40:43]
    v_mfma_f32_16x16x16_bf16 v[44:47], v[166:167], a[14:15], v[44:47]
    s_waitcnt vmcnt(7)
    buffer_load_dwordx4 a[40:43], v6, s[32:35], s39 offen offset:768 nt
    v_mfma_f32_16x16x16_bf16 v[40:43], v[168:169], a[16:17], v[40:43]
    v_mfma_f32_16x16x16_bf16 v[44:47], v[168:169], a[18:19], v[44:47]
    s_waitcnt vmcnt(7)
    buffer_load_dwordx4 a[44:47], v6, s[32:35], s92 offen offset:768 nt
    v_mfma_f32_16x16x16_bf16 v[40:43], v[170:171], a[20:21], v[40:43]
    v_mfma_f32_16x16x16_bf16 v[44:47], v[170:171], a[22:23], v[44:47]
    s_waitcnt vmcnt(7)
    s_add_u32 s26, s25, 0x88000
    buffer_load_dwordx4 a[48:51], v6, s[32:35], s26 offen offset:256 nt
    v_mfma_f32_16x16x16_bf16 v[40:43], v[172:173], a[24:25], v[40:43]
    v_mfma_f32_16x16x16_bf16 v[44:47], v[172:173], a[26:27], v[44:47]
    s_waitcnt vmcnt(5)
    s_add_u32 s38, s25, 0x488000
    buffer_load_dwordx4 a[52:55], v6, s[32:35], s38 offen offset:256 nt
    v_mfma_f32_16x16x16_bf16 v[40:43], v[174:175], a[28:29], v[40:43]
    v_mfma_f32_16x16x16_bf16 v[44:47], v[174:175], a[30:31], v[44:47]
    s_waitcnt vmcnt(5)
    buffer_load_dwordx4 a[56:59], v6, s[32:35], s26 offen offset:768 nt
    v_mfma_f32_16x16x16_bf16 v[40:43], v[176:177], a[32:33], v[40:43]
    v_mfma_f32_16x16x16_bf16 v[44:47], v[176:177], a[34:35], v[44:47]
    s_waitcnt vmcnt(5)
    buffer_load_dwordx4 a[60:63], v6, s[32:35], s38 offen offset:768 nt
    v_mfma_f32_16x16x16_bf16 v[40:43], v[178:179], a[36:37], v[40:43]
    v_mfma_f32_16x16x16_bf16 v[44:47], v[178:179], a[38:39], v[44:47]
    s_waitcnt vmcnt(5)
    buffer_load_dwordx4 a[0:3], v6, s[32:35], s25 offen offset:1024 nt
    global_load_dword v125, v125, s[4:5]
    global_load_dword v126, v126, s[10:11]
    global_load_ushort v18, v18, s[12:13]
    global_load_ushort v127, v127, s[14:15]
    global_load_ushort v89, v23, s[16:17]
    v_mfma_f32_16x16x16_bf16 v[40:43], v[180:181], a[40:41], v[40:43]
    v_mfma_f32_16x16x16_bf16 v[44:47], v[180:181], a[42:43], v[44:47]
    s_waitcnt vmcnt(10)
    s_add_u32 s39, s25, 0x400000
    buffer_load_dwordx4 a[4:7], v6, s[32:35], s39 offen offset:1024 nt
    s_mov_b32 exec_lo, 0x01010101
    s_mov_b32 exec_hi, 0x01010101
    global_load_dword v108, v14, s[20:21]
    s_mov_b64 exec, 1
    global_load_dword v109, v15, s[20:21]
    s_mov_b64 exec, -1
    v_mfma_f32_16x16x16_bf16 v[40:43], v[182:183], a[44:45], v[40:43]
    v_mfma_f32_16x16x16_bf16 v[44:47], v[182:183], a[46:47], v[44:47]
    s_waitcnt vmcnt(12)
    buffer_load_dwordx4 a[8:11], v6, s[32:35], s25 offen offset:1536 nt
    v_mfma_f32_16x16x16_bf16 v[40:43], v[184:185], a[48:49], v[40:43]
    v_mfma_f32_16x16x16_bf16 v[44:47], v[184:185], a[50:51], v[44:47]
    s_waitcnt vmcnt(12)
    buffer_load_dwordx4 a[12:15], v6, s[32:35], s39 offen offset:1536 nt
    v_mfma_f32_16x16x16_bf16 v[40:43], v[186:187], a[52:53], v[40:43]
    v_mfma_f32_16x16x16_bf16 v[44:47], v[186:187], a[54:55], v[44:47]
    s_waitcnt vmcnt(12)
    s_add_u32 s92, s25, 0x80000
    buffer_load_dwordx4 a[16:19], v6, s[32:35], s92 offen offset:1024 nt
    v_mfma_f32_16x16x16_bf16 v[40:43], v[188:189], a[56:57], v[40:43]
    v_mfma_f32_16x16x16_bf16 v[44:47], v[188:189], a[58:59], v[44:47]
    s_waitcnt vmcnt(12)
    s_add_u32 s26, s25, 0x480000
    buffer_load_dwordx4 a[20:23], v6, s[32:35], s26 offen offset:1024 nt
    v_mfma_f32_16x16x16_bf16 v[40:43], v[190:191], a[60:61], v[40:43]
    v_mfma_f32_16x16x16_bf16 v[44:47], v[190:191], a[62:63], v[44:47]
    s_waitcnt vmcnt(12)
    buffer_load_dwordx4 a[24:27], v6, s[32:35], s92 offen offset:1536 nt
    v_mfma_f32_16x16x16_bf16 v[40:43], v[192:193], a[0:1], v[40:43]
    v_mfma_f32_16x16x16_bf16 v[44:47], v[192:193], a[2:3], v[44:47]
    s_waitcnt vmcnt(7)
    buffer_load_dwordx4 a[28:31], v6, s[32:35], s26 offen offset:1536 nt
    v_mov_b32 v22, 0
    v_dot2c_f32_bf16 v22, v125, v126
    v_lshlrev_b32 v127, 16, v127
    v_sub_f32 v127, 1.0, v127
    v_mul_f32 v127, 0xceabfb8f, v127
    v_lshlrev_b32 v18, 16, v18
    v_add_f32_dpp v22, v22, v22 row_ror:1 row_mask:0xf bank_mask:0xf
    s_nop 1
    v_add_f32_dpp v22, v22, v22 row_ror:2 row_mask:0xf bank_mask:0xf
    s_nop 1
    v_add_f32_dpp v22, v22, v22 row_ror:4 row_mask:0xf bank_mask:0xf
    s_nop 1
    v_add_f32_dpp v22, v22, v22 row_ror:8 row_mask:0xf bank_mask:0xf
    v_mov_b32 v125, v22
    s_nop 1
    v_permlane16_swap_b32 v22, v125
    v_add_f32 v22, v22, v125
    v_mov_b32 v125, v22
    s_nop 1
    v_permlane32_swap_b32 v22, v125
    v_add_f32 v22, v22, v125
    v_fma_f32 v22, v22, s40, v127
    v_mfma_f32_16x16x16_bf16 v[40:43], v[194:195], a[4:5], v[40:43]
    v_mfma_f32_16x16x16_bf16 v[44:47], v[194:195], a[6:7], v[44:47]
    s_waitcnt vmcnt(5)
    s_add_u32 s38, s25, 0x8000
    buffer_load_dwordx4 a[32:35], v6, s[32:35], s38 offen offset:1024 nt
    v_mfma_f32_16x16x16_bf16 v[40:43], v[196:197], a[8:9], v[40:43]
    v_mfma_f32_16x16x16_bf16 v[44:47], v[196:197], a[10:11], v[44:47]
    s_waitcnt vmcnt(5)
    s_add_u32 s39, s25, 0x408000
    buffer_load_dwordx4 a[36:39], v6, s[32:35], s39 offen offset:1024 nt
    v_mfma_f32_16x16x16_bf16 v[40:43], v[198:199], a[12:13], v[40:43]
    v_mfma_f32_16x16x16_bf16 v[44:47], v[198:199], a[14:15], v[44:47]
    s_waitcnt vmcnt(5)
    buffer_load_dwordx4 a[40:43], v6, s[32:35], s38 offen offset:1536 nt
    v_mfma_f32_16x16x16_bf16 v[40:43], v[200:201], a[16:17], v[40:43]
    v_mfma_f32_16x16x16_bf16 v[44:47], v[200:201], a[18:19], v[44:47]
    s_waitcnt vmcnt(5)
    buffer_load_dwordx4 a[44:47], v6, s[32:35], s39 offen offset:1536 nt
    v_mfma_f32_16x16x16_bf16 v[40:43], v[202:203], a[20:21], v[40:43]
    v_mfma_f32_16x16x16_bf16 v[44:47], v[202:203], a[22:23], v[44:47]
    s_waitcnt vmcnt(5)
    s_add_u32 s92, s25, 0x88000
    buffer_load_dwordx4 a[48:51], v6, s[32:35], s92 offen offset:1024 nt
    v_mfma_f32_16x16x16_bf16 v[40:43], v[204:205], a[24:25], v[40:43]
    v_mfma_f32_16x16x16_bf16 v[44:47], v[204:205], a[26:27], v[44:47]
    s_waitcnt vmcnt(5)
    s_add_u32 s26, s25, 0x488000
    buffer_load_dwordx4 a[52:55], v6, s[32:35], s26 offen offset:1024 nt
    v_mfma_f32_16x16x16_bf16 v[40:43], v[206:207], a[28:29], v[40:43]
    v_mfma_f32_16x16x16_bf16 v[44:47], v[206:207], a[30:31], v[44:47]
    s_waitcnt vmcnt(5)
    buffer_load_dwordx4 a[56:59], v6, s[32:35], s92 offen offset:1536 nt
    v_mfma_f32_16x16x16_bf16 v[40:43], v[208:209], a[32:33], v[40:43]
    v_mfma_f32_16x16x16_bf16 v[44:47], v[208:209], a[34:35], v[44:47]
    s_waitcnt vmcnt(5)
    buffer_load_dwordx4 a[60:63], v6, s[32:35], s26 offen offset:1536 nt
    v_mfma_f32_16x16x16_bf16 v[40:43], v[210:211], a[36:37], v[40:43]
    v_mfma_f32_16x16x16_bf16 v[44:47], v[210:211], a[38:39], v[44:47]
    s_waitcnt vmcnt(5)
    buffer_load_dwordx4 a[0:3], v6, s[32:35], s25 offen offset:1280 nt
    v_mfma_f32_16x16x16_bf16 v[40:43], v[212:213], a[40:41], v[40:43]
    v_mfma_f32_16x16x16_bf16 v[44:47], v[212:213], a[42:43], v[44:47]
    s_waitcnt vmcnt(5)
    s_add_u32 s38, s25, 0x400000
    buffer_load_dwordx4 a[4:7], v6, s[32:35], s38 offen offset:1280 nt
    v_mfma_f32_16x16x16_bf16 v[40:43], v[214:215], a[44:45], v[40:43]
    v_mfma_f32_16x16x16_bf16 v[44:47], v[214:215], a[46:47], v[44:47]
    s_waitcnt vmcnt(5)
    buffer_load_dwordx4 a[8:11], v6, s[32:35], s25 offen offset:1792 nt
    v_mfma_f32_16x16x16_bf16 v[40:43], v[216:217], a[48:49], v[40:43]
    v_mfma_f32_16x16x16_bf16 v[44:47], v[216:217], a[50:51], v[44:47]
    s_waitcnt vmcnt(5)
    buffer_load_dwordx4 a[12:15], v6, s[32:35], s38 offen offset:1792 nt
    v_mfma_f32_16x16x16_bf16 v[40:43], v[218:219], a[52:53], v[40:43]
    v_mfma_f32_16x16x16_bf16 v[44:47], v[218:219], a[54:55], v[44:47]
    s_waitcnt vmcnt(5)
    s_add_u32 s39, s25, 0x80000
    buffer_load_dwordx4 a[16:19], v6, s[32:35], s39 offen offset:1280 nt
    v_mfma_f32_16x16x16_bf16 v[40:43], v[220:221], a[56:57], v[40:43]
    v_mfma_f32_16x16x16_bf16 v[44:47], v[220:221], a[58:59], v[44:47]
    s_waitcnt vmcnt(5)
    s_add_u32 s92, s25, 0x480000
    buffer_load_dwordx4 a[20:23], v6, s[32:35], s92 offen offset:1280 nt
    v_mfma_f32_16x16x16_bf16 v[40:43], v[222:223], a[60:61], v[40:43]
    v_mfma_f32_16x16x16_bf16 v[44:47], v[222:223], a[62:63], v[44:47]
    s_waitcnt vmcnt(5)
    buffer_load_dwordx4 a[24:27], v6, s[32:35], s39 offen offset:1792 nt
    v_mfma_f32_16x16x16_bf16 v[40:43], v[224:225], a[0:1], v[40:43]
    v_mfma_f32_16x16x16_bf16 v[44:47], v[224:225], a[2:3], v[44:47]
    s_waitcnt vmcnt(5)
    buffer_load_dwordx4 a[28:31], v6, s[32:35], s92 offen offset:1792 nt
    v_mfma_f32_16x16x16_bf16 v[40:43], v[226:227], a[4:5], v[40:43]
    v_mfma_f32_16x16x16_bf16 v[44:47], v[226:227], a[6:7], v[44:47]
    s_waitcnt vmcnt(5)
    s_add_u32 s26, s25, 0x8000
    buffer_load_dwordx4 a[32:35], v6, s[32:35], s26 offen offset:1280 nt
    v_mfma_f32_16x16x16_bf16 v[40:43], v[228:229], a[8:9], v[40:43]
    v_mfma_f32_16x16x16_bf16 v[44:47], v[228:229], a[10:11], v[44:47]
    s_waitcnt vmcnt(5)
    s_add_u32 s38, s25, 0x408000
    buffer_load_dwordx4 a[36:39], v6, s[32:35], s38 offen offset:1280 nt
    v_mfma_f32_16x16x16_bf16 v[40:43], v[230:231], a[12:13], v[40:43]
    v_mfma_f32_16x16x16_bf16 v[44:47], v[230:231], a[14:15], v[44:47]
    s_waitcnt vmcnt(5)
    buffer_load_dwordx4 a[40:43], v6, s[32:35], s26 offen offset:1792 nt
    v_mfma_f32_16x16x16_bf16 v[40:43], v[232:233], a[16:17], v[40:43]
    v_mfma_f32_16x16x16_bf16 v[44:47], v[232:233], a[18:19], v[44:47]
    s_waitcnt vmcnt(5)
    buffer_load_dwordx4 a[44:47], v6, s[32:35], s38 offen offset:1792 nt
    v_mfma_f32_16x16x16_bf16 v[40:43], v[234:235], a[20:21], v[40:43]
    v_mfma_f32_16x16x16_bf16 v[44:47], v[234:235], a[22:23], v[44:47]
    s_waitcnt vmcnt(5)
    s_add_u32 s39, s25, 0x88000
    buffer_load_dwordx4 a[48:51], v6, s[32:35], s39 offen offset:1280 nt
    v_mfma_f32_16x16x16_bf16 v[40:43], v[236:237], a[24:25], v[40:43]
    v_mfma_f32_16x16x16_bf16 v[44:47], v[236:237], a[26:27], v[44:47]
    s_waitcnt vmcnt(5)
    s_add_u32 s92, s25, 0x488000
    buffer_load_dwordx4 a[52:55], v6, s[32:35], s92 offen offset:1280 nt
    v_mfma_f32_16x16x16_bf16 v[40:43], v[238:239], a[28:29], v[40:43]
    v_mfma_f32_16x16x16_bf16 v[44:47], v[238:239], a[30:31], v[44:47]
    s_waitcnt vmcnt(5)
    buffer_load_dwordx4 a[56:59], v6, s[32:35], s39 offen offset:1792 nt
    v_mfma_f32_16x16x16_bf16 v[40:43], v[240:241], a[32:33], v[40:43]
    v_mfma_f32_16x16x16_bf16 v[44:47], v[240:241], a[34:35], v[44:47]
    s_waitcnt vmcnt(5)
    buffer_load_dwordx4 a[60:63], v6, s[32:35], s92 offen offset:1792 nt
    v_mfma_f32_16x16x16_bf16 v[40:43], v[242:243], a[36:37], v[40:43]
    v_mfma_f32_16x16x16_bf16 v[44:47], v[242:243], a[38:39], v[44:47]
    s_waitcnt lgkmcnt(0)
    s_barrier
    ds_read_b128 v[52:55], v13 offset:9216
    ds_read_b128 v[60:63], v13 offset:9280
    v_readfirstlane_b32 s37, v21
    s_cmp_eq_u32 s37, 0
    s_cbranch_scc1 L_late
L_lateb:
    v_readfirstlane_b32 s45, v20
    v_readfirstlane_b32 s36, v86
    s_lshl_b32 s37, 8, s93
    s_cmp_eq_u32 s36, s37
    s_cselect_b64 s[54:55], -1, 0
    s_cselect_b32 s95, 1999936, -1
    s_waitcnt lgkmcnt(0)
    v_max3_f32 v17, v52, v53, v54
    v_max_f32 v17, v17, v55
    v_and_b32 v17, s50, v17
    v_sub_f32 v52, v52, v17
    v_sub_f32 v53, v53, v17
    v_sub_f32 v54, v54, v17
    v_sub_f32 v55, v55, v17
    v_exp_f32 v76, v52
    v_exp_f32 v77, v53
    v_exp_f32 v78, v54
    v_exp_f32 v79, v55
    s_and_b32 s46, s45, s44
    s_add_u32 s47, s45, 0x2a5
    s_lshr_b32 s27, s45, 11
    s_add_u32 s47, s47, s27
    s_and_b32 s47, s47, s44
    s_add_u32 s48, s45, 0x13b
    s_lshr_b32 s27, s45, 22
    s_add_u32 s48, s48, s27
    s_and_b32 s48, s48, s44
    s_add_u32 s49, s45, 0x6d2
    s_and_b32 s49, s49, s44
    v_mul_f32 v57, v76, v60
    v_fmac_f32 v57, v77, v61
    v_fmac_f32 v57, v78, v62
    v_fmac_f32 v57, v79, v63
    s_mov_b32 vcc_lo, 0xaaaaaaaa
    s_mov_b32 vcc_hi, 0xaaaaaaaa
    v_mov_b32 v5, s46
    v_mov_b32 v84, s47
    v_mov_b32 v82, s48
    v_mov_b32 v83, s49
    v_or_b32 v80, s46, v17
    v_cndmask_b32 v5, v5, v82, vcc
    v_cndmask_b32 v7, v84, v83, vcc
    v_and_or_b32 v81, v57, s50, v84
    s_mov_b64 vcc, s[54:55]
    s_mov_b64 exec, 1
    s_cbranch_vccz L_fml
    global_store_dwordx4 v15, v[80:83], s[20:21]
L_fmlb:
    s_mov_b64 exec, -1
    s_waitcnt vmcnt(5)
    v_mfma_f32_16x16x16_bf16 v[40:43], v[244:245], a[40:41], v[40:43]
    v_mfma_f32_16x16x16_bf16 v[44:47], v[244:245], a[42:43], v[44:47]
    s_waitcnt vmcnt(4)
    v_mfma_f32_16x16x16_bf16 v[40:43], v[246:247], a[44:45], v[40:43]
    v_mfma_f32_16x16x16_bf16 v[44:47], v[246:247], a[46:47], v[44:47]
    s_waitcnt vmcnt(3)
    v_mfma_f32_16x16x16_bf16 v[40:43], v[248:249], a[48:49], v[40:43]
    v_mfma_f32_16x16x16_bf16 v[44:47], v[248:249], a[50:51], v[44:47]
    s_waitcnt vmcnt(2)
    v_mfma_f32_16x16x16_bf16 v[40:43], v[250:251], a[52:53], v[40:43]
    v_mfma_f32_16x16x16_bf16 v[44:47], v[250:251], a[54:55], v[44:47]
    s_waitcnt vmcnt(1)
    v_mfma_f32_16x16x16_bf16 v[40:43], v[252:253], a[56:57], v[40:43]
    v_mfma_f32_16x16x16_bf16 v[44:47], v[252:253], a[58:59], v[44:47]
    s_waitcnt vmcnt(0)
    v_mfma_f32_16x16x16_bf16 v[40:43], v[254:255], a[60:61], v[40:43]
    v_mfma_f32_16x16x16_bf16 v[44:47], v[254:255], a[62:63], v[44:47]
    s_cmp_lt_u32 s23, 24
    s_nop 5
    ds_write_b128 v10, v[40:43]
    ds_write_b128 v10, v[44:47] offset:1152
    s_waitcnt lgkmcnt(0)
    s_barrier
    ds_read_b64 v[48:49], v11 offset:0
    ds_read_b64 v[50:51], v11 offset:2304
    ds_read_b64 v[52:53], v11 offset:4608
    ds_read_b64 v[54:55], v11 offset:6912
    global_load_dwordx4 v[96:99], v12, s[20:21] sc1
    s_waitcnt lgkmcnt(2)
    v_pk_mul_f32 v[48:49], v[48:49], v[76:77] op_sel_hi:[1,0]
    v_pk_fma_f32 v[48:49], v[50:51], v[76:77], v[48:49] op_sel:[0,1,0] op_sel_hi:[1,1,1]
    s_waitcnt lgkmcnt(0)
    v_pk_mul_f32 v[52:53], v[52:53], v[78:79] op_sel_hi:[1,0]
    v_pk_fma_f32 v[52:53], v[54:55], v[78:79], v[52:53] op_sel:[0,1,0] op_sel_hi:[1,1,1]
    v_pk_add_f32 v[48:49], v[48:49], v[52:53]
    v_and_or_b32 v48, v48, s50, v5
    v_and_or_b32 v49, v49, s50, v7
    s_cbranch_vccz L_fo
    global_store_dwordx2 v14, v[48:49], s[20:21]
L_fob:
    s_cbranch_scc1 L_fin
    global_load_dwordx4 v[100:103], v16, s[20:21] offset:0 sc1
    global_load_dwordx4 v[104:107], v16, s[20:21] offset:1024 sc1
    s_mov_b32 s51, 2000000
    s_waitcnt vmcnt(3)
L_pollA:
    v_xor_b32 v112, s46, v96
    v_xor_b32 v113, s47, v97
    v_readfirstlane_b32 s57, v112
    v_xor_b32 v114, s48, v98
    v_xor_b32 v115, s49, v99
    v_or3_b32 v50, v112, v113, v114
    v_bitop3_b32 v50, v50, v115, s44 bitop3:0xa8
    v_cmp_ne_u32 s[58:59], 0, v50
    v_subrev_f32 v60, s57, v112
    v_subrev_f32 v19, s57, v22
    s_cmp_lg_u64 s[58:59], 0
    s_cbranch_scc1 L_retryA
L_goA:
    v_max_f32 v56, v60, v19
    v_exp_f32 v19, v19
    v_exp_f32 v60, v60
    v_cmp_lt_f32 vcc, 0x41800000, v56
    v_mul_f32 v57, v60, v113
    s_cbranch_vccnz L_slow
L_back4:
    v_mul_f32 v58, v19, v18
    v_add_f32_dpp v57, v57, v57 quad_perm:[1,0,3,2] row_mask:0xf bank_mask:0xf
    s_nop 1
    v_add_f32_dpp v57, v57, v57 row_ror:4 row_mask:0xf bank_mask:0xf
    s_nop 1
    v_add_f32_dpp v57, v57, v57 row_ror:8 row_mask:0xf bank_mask:0xf
    v_mov_b32 v59, v57
    s_nop 1
    v_permlane16_swap_b32 v57, v59
    v_add_f32 v57, v57, v59
    v_mov_b32 v59, v57
    s_nop 1
    v_permlane32_swap_b32 v57, v59
    v_add_f32 v57, v57, v59
    v_add_f32 v57, v57, v19
    v_rcp_f32 v57, v57
L_pollB:
    s_waitcnt vmcnt(1)
    v_xor_b32 v116, s46, v100
    v_xor_b32 v117, s47, v101
    v_xor_b32 v118, s48, v102
    v_xor_b32 v119, s49, v103
    v_or3_b32 v50, v116, v117, v118
    v_bitop3_b32 v50, v50, v119, s44 bitop3:0xa8
    v_cmp_ne_u32 s[60:61], 0, v50
    s_waitcnt vmcnt(0)
    v_xor_b32 v120, s46, v104
    v_xor_b32 v121, s47, v105
    v_xor_b32 v122, s48, v106
    v_xor_b32 v123, s49, v107
    v_or3_b32 v50, v120, v121, v122
    v_bitop3_b32 v50, v50, v123, s44 bitop3:0xa8
    v_cmp_ne_u32 s[62:63], 0, v50
    v_mul_f32_dpp v64, v60, v116 quad_perm:[0,0,0,0] row_mask:0xf bank_mask:0xf
    v_mul_f32_dpp v65, v60, v117 quad_perm:[0,0,0,0] row_mask:0xf bank_mask:0xf
    v_mul_f32_dpp v66, v60, v118 quad_perm:[0,0,0,0] row_mask:0xf bank_mask:0xf
    v_mul_f32_dpp v67, v60, v119 quad_perm:[0,0,0,0] row_mask:0xf bank_mask:0xf
    s_or_b64 s[52:53], s[60:61], s[62:63]
    s_cbranch_scc1 L_retryB
L_go:
    v_fmac_f32_dpp v64, v60, v120 quad_perm:[1,1,1,1] row_mask:0xf bank_mask:0xf
    v_fmac_f32_dpp v65, v60, v121 quad_perm:[1,1,1,1] row_mask:0xf bank_mask:0xf
    v_fmac_f32_dpp v66, v60, v122 quad_perm:[1,1,1,1] row_mask:0xf bank_mask:0xf
    v_fmac_f32_dpp v67, v60, v123 quad_perm:[1,1,1,1] row_mask:0xf bank_mask:0xf
    s_nop 0
    v_permlane16_swap_b32 v64, v65
    v_permlane16_swap_b32 v66, v67
    v_add_f32 v64, v64, v65
    v_add_f32 v66, v66, v67
    s_nop 1
    v_permlane32_swap_b32 v64, v66
    v_add_f32 v64, v64, v66
    s_nop 1
    v_add_f32_dpp v64, v64, v64 row_ror:4 row_mask:0xf bank_mask:0xf
    s_nop 1
    v_add_f32_dpp v64, v64, v64 row_ror:8 row_mask:0xf bank_mask:0xf
    v_add_f32 v64, v64, v58
    v_mul_f32 v64, v57, v64
    s_mov_b32 exec_lo, 0x000f000f
    s_mov_b32 exec_hi, 0x000f000f
    v_cvt_pk_bf16_f32 v64, v64, v64
    global_store_short v23, v64, s[16:17]
L_fin:
L_end:
    s_endpgm
L_el1:
    s_mov_b32 s88, 1
    s_atomic_add s88, s[20:21], 0xc0000 glc
    s_branch L_el1b
L_el2:
    s_waitcnt lgkmcnt(0)
    v_mov_b32 v92, s88
    s_mov_b64 exec, 1
    v_add_u32 v92, 1, v92
    global_atomic_cmpswap_x2 v94, v[92:95], s[18:19] sc1
    s_mov_b64 exec, -1
    s_branch L_el2b
L_fml:
    global_store_dwordx4 v15, v[80:83], s[86:87] sc1
    s_branch L_fmlb
L_fo:
    global_store_dwordx2 v14, v[48:49], s[86:87] sc1
    s_branch L_fob
L_rep:
    s_xor_b32 s27, s22, 0
    s_lshl_b32 s27, s27, 2
    s_add_u32 s27, s27, 64
    s_lshl_b32 s94, 1, s93
    s_atomic_add s94, s[18:19], s27
    s_branch L_repb
L_late:
    s_mov_b64 exec, 1
    global_atomic_add v92, v88, v93, s[20:21] sc0 sc1
    s_waitcnt vmcnt(0)
    v_add_u32 v92, 1, v92
    global_atomic_cmpswap_x2 v[90:91], v94, v[92:95], s[18:19] sc0 sc1
    s_waitcnt vmcnt(0)
    v_cmp_eq_u32 vcc, 0, v91
    s_nop 1
    v_cndmask_b32 v90, v90, v92, vcc
    v_mov_b32 v20, v90
    s_mov_b64 exec, -1
    s_branch L_lateb
L_retryA:
    s_sub_u32 s51, s51, 1
    s_cbranch_scc1 L_goA
    s_waitcnt vmcnt(1)
    v_xor_b32 v116, s46, v100
    v_xor_b32 v117, s47, v101
    v_xor_b32 v118, s48, v102
    v_xor_b32 v119, s49, v103
    v_or3_b32 v50, v116, v117, v118
    v_bitop3_b32 v50, v50, v119, s44 bitop3:0xa8
    v_cmp_ne_u32 s[60:61], 0, v50
    s_waitcnt vmcnt(0)
    v_xor_b32 v120, s46, v104
    v_xor_b32 v121, s47, v105
    v_xor_b32 v122, s48, v106
    v_xor_b32 v123, s49, v107
    v_or3_b32 v50, v120, v121, v122
    v_bitop3_b32 v50, v50, v123, s44 bitop3:0xa8
    v_cmp_ne_u32 s[62:63], 0, v50
    s_cmp_lt_u32 s51, s95
    s_cselect_b32 s27, s51, 0
    s_bitcmp1_b32 s27, 0
    s_cbranch_scc1 L_farA
    s_mov_b64 exec, s[58:59]
    global_load_dwordx4 v[96:99], v12, s[20:21] sc1
    s_mov_b64 exec, s[60:61]
    global_load_dwordx4 v[100:103], v16, s[20:21] offset:0 sc1
    s_mov_b64 exec, s[62:63]
    global_load_dwordx4 v[104:107], v16, s[20:21] offset:1024 sc1
    s_mov_b64 exec, -1
    s_waitcnt vmcnt(0)
    s_branch L_pollA
L_farA:
    s_mov_b64 exec, s[58:59]
    global_load_dwordx4 v[96:99], v12, s[86:87] sc1
    s_mov_b64 exec, s[60:61]
    global_load_dwordx4 v[100:103], v16, s[86:87] offset:0 sc1
    s_mov_b64 exec, s[62:63]
    global_load_dwordx4 v[104:107], v16, s[86:87] offset:1024 sc1
    s_mov_b64 exec, -1
    s_waitcnt vmcnt(0)
    s_branch L_pollA
L_retryB:
    s_sub_u32 s51, s51, 1
    s_cbranch_scc1 L_go
    s_cmp_lt_u32 s51, s95
    s_cselect_b32 s27, s51, 0
    s_bitcmp1_b32 s27, 0
    s_cbranch_scc1 L_farB
    s_mov_b64 exec, s[60:61]
    global_load_dwordx4 v[100:103], v16, s[20:21] offset:0 sc1
    s_mov_b64 exec, s[62:63]
    global_load_dwordx4 v[104:107], v16, s[20:21] offset:1024 sc1
    s_mov_b64 exec, -1
    s_waitcnt vmcnt(0)
    s_branch L_pollB
L_farB:
    s_mov_b64 exec, s[60:61]
    global_load_dwordx4 v[100:103], v16, s[86:87] offset:0 sc1
    s_mov_b64 exec, s[62:63]
    global_load_dwordx4 v[104:107], v16, s[86:87] offset:1024 sc1
    s_mov_b64 exec, -1
    s_waitcnt vmcnt(0)
    s_branch L_pollB
L_slow:
    v_max_f32 v56, v112, v22
    s_nop 1
    v_max_f32_dpp v56, v56, v56 quad_perm:[1,0,3,2] row_mask:0xf bank_mask:0xf
    s_nop 1
    v_max_f32_dpp v56, v56, v56 row_ror:4 row_mask:0xf bank_mask:0xf
    s_nop 1
    v_max_f32_dpp v56, v56, v56 row_ror:8 row_mask:0xf bank_mask:0xf
    s_nop 1
    v_mov_b32 v59, v56
    s_nop 1
    v_permlane16_swap_b32 v56, v59
    v_max_f32 v56, v56, v59
    v_mov_b32 v59, v56
    s_nop 1
    v_permlane32_swap_b32 v56, v59
    v_max_f32 v56, v56, v59
    v_sub_f32 v60, v112, v56
    v_sub_f32 v19, v22, v56
    v_exp_f32 v60, v60
    v_exp_f32 v19, v19
    s_nop 0
    v_mul_f32 v57, v60, v113
    s_branch L_back4
.section .rodata,"a"
.p2align 6
.amdhsa_kernel standalone__tree_speculative_verify_tree_attention_over_candidate_token_tree__decode_kernel
  .amdhsa_next_free_vgpr 320
  .amdhsa_next_free_sgpr 96
  .amdhsa_accum_offset 256
  .amdhsa_group_segment_fixed_size 0
  .amdhsa_kernarg_size 72
  .amdhsa_user_sgpr_count 2
  .amdhsa_user_sgpr_kernarg_segment_ptr 1
  .amdhsa_system_sgpr_workgroup_id_x 1
.end_amdhsa_kernel
```
